```python
import torch

def _softmax(x, axis=-1):
    return torch.softmax(x, dim=axis)
def _gelu(x):
    return torch.nn.functional.gelu(x, approximate="tanh")
def _silu(x):
    return torch.nn.functional.silu(x)
def _sigmoid(x):
    return torch.sigmoid(x)
def _layernorm(x, axis=-1, eps=1e-5):
    m = x.mean(dim=axis, keepdim=True)
    v = x.var(dim=axis, keepdim=True, unbiased=False)
    return (x - m) / torch.sqrt(v + eps)
def _scatter_add(tgt, idx, src, axis=0):
    return tgt.clone().index_add_(axis, idx, src)
def _segment_sum(src, seg, n):
    out = torch.zeros((n,) + src.shape[1:], dtype=src.dtype)
    return out.index_add_(0, seg, src)
def _pad(x, pw):
    flat = tuple(v for pair in reversed(pw) for v in pair)
    return torch.nn.functional.pad(x, flat)

kernel_name = 'parallel_sum__ssm_conv_s4d__glu_gated_reglu__prompt'

def setup_inputs():

    _w = (lambda a: (lambda t: t.to(torch.bfloat16) if t.is_floating_point() else t)(torch.as_tensor(a)))
    def _A_setup():
        Bsz, L, D, N = 1, 2048, 512, 128
        return {
            "u": _w((lambda *s: torch.randn(*s, dtype=torch.bfloat16) * 0.05)(Bsz, L, D)),
            "log_A_real": _w((lambda *s: torch.randn(*s, dtype=torch.bfloat16) * 3.2)(D, N) * 0.5),
            "A_imag": _w((lambda *s: torch.randn(*s, dtype=torch.bfloat16) * 0.05)(D, N) * 3.14),
            "C_real": _w((lambda *s: torch.randn(*s, dtype=torch.bfloat16) * 0.1)(D, N) / N ** 0.5),
            "C_imag": _w((lambda *s: torch.randn(*s, dtype=torch.bfloat16) * 0.2)(D, N) / N ** 0.5),
            "log_dt": _w((lambda *s: torch.randn(*s, dtype=torch.bfloat16) * 0.05)(D) * 0.5 - 4.0),
            "D_skip": _w((lambda *s: torch.randn(*s, dtype=torch.bfloat16) * 0.05)(D)),
        }
    _A_in = _A_setup()

    def _B_setup():
        B, S, D, F = 1, 2048, 512, 1376
        return {
            "x": _w((lambda *s: torch.randn(*s, dtype=torch.bfloat16) * 0.05)(B, S, D)),
            "W_gate": _w((lambda *s: torch.randn(*s, dtype=torch.bfloat16) * 0.4)(D, F) * (2.0 / D) ** 0.5),
            "W_up": _w((lambda *s: torch.randn(*s, dtype=torch.bfloat16) * 0.4)(D, F) * (2.0 / D) ** 0.5),
            "W_down": _w((lambda *s: torch.randn(*s, dtype=torch.bfloat16) * 0.4)(F, D) * (1.0 / F) ** 0.5),
        }
    _B_in = _B_setup()

    return {
        "A_u": _A_in["u"],
        "A_log_A_real": _A_in["log_A_real"],
        "A_A_imag": _A_in["A_imag"],
        "A_C_real": _A_in["C_real"],
        "A_C_imag": _A_in["C_imag"],
        "A_log_dt": _A_in["log_dt"],
        "A_D_skip": _A_in["D_skip"],
        "B_x": _B_in["x"],
        "B_W_gate": _B_in["W_gate"],
        "B_W_up": _B_in["W_up"],
        "B_W_down": _B_in["W_down"],
    }

def reference(A_u, A_log_A_real, A_A_imag, A_C_real, A_C_imag, A_log_dt, A_D_skip, B_x, B_W_gate, B_W_up, B_W_down):
    def _A_ref(u, log_A_real, A_imag, C_real, C_imag, log_dt, D_skip):
        L = u.shape[1]
        dt = torch.exp(log_dt)
        A = -torch.exp(log_A_real) + 1j * A_imag
        C = (C_real + 1j * C_imag) * dt[:, None]
        pos = (lambda x, dt: x.to(dt))(torch.arange(L), log_dt.dtype)
        P = torch.exp((A * dt[:, None])[:, :, None] * pos[None, None, :])
        K = 2.0 * torch.einsum("dn,dnl->dl", C, P).real
        L2 = 2 * L
        u_t = (lambda x, *d: x.permute(*d))(u, 0, 2, 1)
        Kf = (lambda x, *a, **k: torch.fft.rfft(x.float(), *a, **k))(K, L2)
        Uf = (lambda x, *a, **k: torch.fft.rfft(x.float(), *a, **k))(u_t, L2)
        y = (lambda x, *a, **k: torch.fft.irfft(x, *a, **k).to(torch.bfloat16))(Uf * Kf[None, :, :], L2)[:, :, :L]
        y = (lambda x, *d: x.permute(*d))(y, 0, 2, 1)
        return y + u * D_skip[None, None, :]

    def _B_ref(x, W_gate, W_up, W_down):
        gate = torch.einsum("bsd,df->bsf", x, W_gate)
        up = torch.einsum("bsd,df->bsf", x, W_up)
        gate = gate * (lambda x, dt: x.to(dt))(gate > 0, gate.dtype)
        h = gate * up
        return torch.einsum("bsf,fd->bsd", h, W_down)

    x = A_u
    xn = _layernorm(x, axis=-1)
    return x + _A_ref(xn, A_log_A_real, A_A_imag, A_C_real, A_C_imag, A_log_dt, A_D_skip) + _B_ref(xn, B_W_gate, B_W_up, B_W_down)
```

```asm
; @launch kernel=k1_kernel grid=(256,1,1) block=(512,1,1) lds=75776
; @launch kernel=k2_kernel grid=(256,1,1) block=(512,1,1) lds=147456
; @launch kernel=k3_kernel grid=(256,1,1) block=(768,1,1) lds=139264
.amdgcn_target "amdgcn-amd-amdhsa--gfx950"
.text
.globl k1_kernel
.type k1_kernel,@function
.globl k2_kernel
.type k2_kernel,@function
.globl k3_kernel
.type k3_kernel,@function
.p2align 8
k1_kernel:
  s_cmp_ge_u32 s2, 256
  s_cbranch_scc1 k1_exit
  v_lshrrev_b32 v2, 6, v0
  v_and_b32 v1, 63, v0
  v_readfirstlane_b32 s44, v2
  s_cmp_ge_u32 s44, 4
  s_cbranch_scc1 k1_ln
  s_load_dwordx8 s[4:11], s[0:1], 8
  s_load_dwordx2 s[12:13], s[0:1], 40
  s_load_dwordx2 s[14:15], s[0:1], 104
  s_and_b32 s41, s2, 7
  s_lshr_b32 s42, s2, 3
  s_lshr_b32 s43, s42, 2
  s_lshl_b32 s43, s43, 6
  s_lshl_b32 s41, s41, 3
  s_add_u32 s41, s41, s43
  s_and_b32 s42, s42, 3
  s_lshl_b32 s42, s42, 1
  s_add_u32 s41, s41, s42
  s_lshr_b32 s45, s44, 1
  s_and_b32 s46, s44, 1
  s_add_u32 s47, s41, s45
  s_lshl_b32 s48, s46, 6
  v_add_u32 v3, s48, v1
  s_lshl_b32 s49, s47, 8
  v_lshlrev_b32 v4, 1, v3
  s_lshl_b32 s50, s47, 1
  v_mov_b32 v5, s50
  s_waitcnt lgkmcnt(0)
  s_mov_b32 s16, s4
  s_mov_b32 s17, s5
  s_mov_b32 s18, 131072
  s_mov_b32 s19, 0x00020000
  s_mov_b32 s32, s12
  s_mov_b32 s33, s13
  s_mov_b32 s34, 1024
  s_mov_b32 s35, 0x00020000
  buffer_load_ushort v8, v4, s[16:19], s49 offen
  buffer_load_ushort v12, v5, s[32:35], 0 offen
  s_mov_b32 s20, s6
  s_mov_b32 s21, s7
  s_mov_b32 s22, 131072
  s_mov_b32 s23, 0x00020000
  buffer_load_ushort v9, v4, s[20:23], s49 offen
  s_mov_b32 s24, s8
  s_mov_b32 s25, s9
  s_mov_b32 s26, 131072
  s_mov_b32 s27, 0x00020000
  buffer_load_ushort v10, v4, s[24:27], s49 offen
  s_mov_b32 s28, s10
  s_mov_b32 s29, s11
  s_mov_b32 s30, 131072
  s_mov_b32 s31, 0x00020000
  buffer_load_ushort v11, v4, s[28:31], s49 offen
  s_add_u32 s36, s14, 4718592
  s_addc_u32 s37, s15, 0
  s_mov_b32 s38, 1572864
  s_mov_b32 s39, 0x00020000
  s_mul_i32 s51, s45, 33536
  v_lshlrev_b32 v6, 2, v3
  v_add_u32 v6, s51, v6
  v_and_b32 v7, 15, v1
  v_lshrrev_b32 v2, 4, v1
  v_mul_u32_u24 v13, 544, v7
  v_lshl_add_u32 v13, v2, 4, v13
  v_add_u32 v100, s51, v13
  s_mul_i32 s52, s46, 8704
  v_add_u32 v101, s52, v100
  s_cmp_eq_u32 s46, 0
  s_mov_b32 s64, 0x00000000
  s_mov_b32 s65, 0x3f800000
  s_cselect_b32 s56, s64, 0x44c00000
  s_cselect_b32 s60, s65, 0x43800000
  s_mov_b32 s64, 0x40800000
  s_mov_b32 s65, 0x3f800000
  s_cselect_b32 s57, s64, 0x44010000
  s_cselect_b32 s61, s65, 0x43800000
  s_mov_b32 s64, 0x43800000
  s_mov_b32 s65, 0x40000000
  s_cselect_b32 s58, s64, 0x45800800
  s_cselect_b32 s62, s65, 0x00000000
  s_mov_b32 s64, 0x44000000
  s_mov_b32 s65, 0x43800000
  s_cselect_b32 s59, s64, 0x45800800
  s_cselect_b32 s63, s65, 0x00000000
  v_mov_b32 v14, s56
  v_mov_b32 v15, s60
  v_cmp_eq_u32 vcc, 1, v2
  v_mov_b32 v16, s57
  v_mov_b32 v17, s61
  v_cndmask_b32 v14, v14, v16, vcc
  v_cndmask_b32 v15, v15, v17, vcc
  v_cmp_eq_u32 vcc, 2, v2
  v_mov_b32 v16, s58
  v_mov_b32 v17, s62
  v_cndmask_b32 v14, v14, v16, vcc
  v_cndmask_b32 v15, v15, v17, vcc
  v_cmp_eq_u32 vcc, 3, v2
  v_mov_b32 v16, s59
  v_mov_b32 v17, s63
  v_cndmask_b32 v14, v14, v16, vcc
  v_cndmask_b32 v15, v15, v17, vcc
  v_cvt_f32_u32 v16, v7
  v_fmac_f32 v14, 0x41000000, v16
  s_add_u32 s53, s51, -2048
  s_add_u32 s54, s51, 33464
  s_add_u32 s57, s51, 30974
  s_add_u32 s58, s51, 32000
  v_mov_b32 v19, s54
  v_mov_b32 v20, v14
  v_add_f32 v21, v20, v15
  v_add_f32 v22, v21, v15
  v_add_f32 v23, v22, v15
  v_add_f32 v24, 0x43000000, v14
  v_add_f32 v25, v24, v15
  v_add_f32 v26, v25, v15
  v_add_f32 v27, v26, v15
  v_cvt_pk_bf16_f32 v102, v20, v20
  v_cvt_u32_f32 v17, v20
  v_and_b32 v16, 0xffff0000, v102
  v_cmp_eq_u32 vcc, v16, v20
  v_and_b32 v102, 0xffff, v102
  v_lshl_add_u32 v102, v102, 1, s53
  v_cndmask_b32 v102, v19, v102, vcc
  v_lshlrev_b32 v16, 1, v17
  v_cmp_gt_u32 vcc, 256, v17
  v_sub_u32 v18, s57, v16
  v_sub_u32 v112, s58, v16
  v_cndmask_b32 v102, v102, v18, vcc
  v_cmp_ge_u32 vcc, 256, v17
  s_nop 1
  v_cndmask_b32 v112, v19, v112, vcc
  v_cvt_pk_bf16_f32 v103, v21, v21
  v_cvt_u32_f32 v17, v21
  v_and_b32 v16, 0xffff0000, v103
  v_cmp_eq_u32 vcc, v16, v21
  v_and_b32 v103, 0xffff, v103
  v_lshl_add_u32 v103, v103, 1, s53
  v_cndmask_b32 v103, v19, v103, vcc
  v_lshlrev_b32 v16, 1, v17
  v_cmp_gt_u32 vcc, 256, v17
  v_sub_u32 v18, s57, v16
  v_sub_u32 v113, s58, v16
  v_cndmask_b32 v103, v103, v18, vcc
  v_cmp_ge_u32 vcc, 256, v17
  s_nop 1
  v_cndmask_b32 v113, v19, v113, vcc
  v_cvt_pk_bf16_f32 v104, v22, v22
  v_cvt_u32_f32 v17, v22
  v_and_b32 v16, 0xffff0000, v104
  v_cmp_eq_u32 vcc, v16, v22
  v_and_b32 v104, 0xffff, v104
  v_lshl_add_u32 v104, v104, 1, s53
  v_cndmask_b32 v104, v19, v104, vcc
  v_lshlrev_b32 v16, 1, v17
  v_cmp_gt_u32 vcc, 256, v17
  v_sub_u32 v18, s57, v16
  v_sub_u32 v114, s58, v16
  v_cndmask_b32 v104, v104, v18, vcc
  v_cmp_ge_u32 vcc, 256, v17
  s_nop 1
  v_cndmask_b32 v114, v19, v114, vcc
  v_cvt_pk_bf16_f32 v105, v23, v23
  v_cvt_u32_f32 v17, v23
  v_and_b32 v16, 0xffff0000, v105
  v_cmp_eq_u32 vcc, v16, v23
  v_and_b32 v105, 0xffff, v105
  v_lshl_add_u32 v105, v105, 1, s53
  v_cndmask_b32 v105, v19, v105, vcc
  v_lshlrev_b32 v16, 1, v17
  v_cmp_gt_u32 vcc, 256, v17
  v_sub_u32 v18, s57, v16
  v_sub_u32 v115, s58, v16
  v_cndmask_b32 v105, v105, v18, vcc
  v_cmp_ge_u32 vcc, 256, v17
  s_nop 1
  v_cndmask_b32 v115, v19, v115, vcc
  v_cvt_pk_bf16_f32 v106, v24, v24
  v_cvt_u32_f32 v17, v24
  v_and_b32 v16, 0xffff0000, v106
  v_cmp_eq_u32 vcc, v16, v24
  v_and_b32 v106, 0xffff, v106
  v_lshl_add_u32 v106, v106, 1, s53
  v_cndmask_b32 v106, v19, v106, vcc
  v_lshlrev_b32 v16, 1, v17
  v_cmp_gt_u32 vcc, 256, v17
  v_sub_u32 v18, s57, v16
  v_sub_u32 v116, s58, v16
  v_cndmask_b32 v106, v106, v18, vcc
  v_cmp_ge_u32 vcc, 256, v17
  s_nop 1
  v_cndmask_b32 v116, v19, v116, vcc
  v_cvt_pk_bf16_f32 v107, v25, v25
  v_cvt_u32_f32 v17, v25
  v_and_b32 v16, 0xffff0000, v107
  v_cmp_eq_u32 vcc, v16, v25
  v_and_b32 v107, 0xffff, v107
  v_lshl_add_u32 v107, v107, 1, s53
  v_cndmask_b32 v107, v19, v107, vcc
  v_lshlrev_b32 v16, 1, v17
  v_cmp_gt_u32 vcc, 256, v17
  v_sub_u32 v18, s57, v16
  v_sub_u32 v117, s58, v16
  v_cndmask_b32 v107, v107, v18, vcc
  v_cmp_ge_u32 vcc, 256, v17
  s_nop 1
  v_cndmask_b32 v117, v19, v117, vcc
  v_cvt_pk_bf16_f32 v108, v26, v26
  v_cvt_u32_f32 v17, v26
  v_and_b32 v16, 0xffff0000, v108
  v_cmp_eq_u32 vcc, v16, v26
  v_and_b32 v108, 0xffff, v108
  v_lshl_add_u32 v108, v108, 1, s53
  v_cndmask_b32 v108, v19, v108, vcc
  v_lshlrev_b32 v16, 1, v17
  v_cmp_gt_u32 vcc, 256, v17
  v_sub_u32 v18, s57, v16
  v_sub_u32 v118, s58, v16
  v_cndmask_b32 v108, v108, v18, vcc
  v_cmp_ge_u32 vcc, 256, v17
  s_nop 1
  v_cndmask_b32 v118, v19, v118, vcc
  v_cvt_pk_bf16_f32 v109, v27, v27
  v_cvt_u32_f32 v17, v27
  v_and_b32 v16, 0xffff0000, v109
  v_cmp_eq_u32 vcc, v16, v27
  v_and_b32 v109, 0xffff, v109
  v_lshl_add_u32 v109, v109, 1, s53
  v_cndmask_b32 v109, v19, v109, vcc
  v_lshlrev_b32 v16, 1, v17
  v_cmp_gt_u32 vcc, 256, v17
  v_sub_u32 v18, s57, v16
  v_sub_u32 v119, s58, v16
  v_cndmask_b32 v109, v109, v18, vcc
  v_cmp_ge_u32 vcc, 256, v17
  s_nop 1
  v_cndmask_b32 v119, v19, v119, vcc
  v_mov_b32 v20, 0
  v_mov_b32 v21, 0
  v_mov_b32 v22, 0
  v_mov_b32 v23, 0
  v_and_b32 v16, 1, v1
  v_lshlrev_b32 v16, 4, v16
  s_mul_i32 s59, s46, 1024
  s_add_u32 s59, s59, s57
  v_add_u32 v16, s59, v16
  ds_write_b128 v16, v[20:23] offset:2
  v_lshlrev_b32 v130, 4, v3
  s_add_u32 s55, s51, 30464
  v_add_u32 v110, s55, v130
  s_mul_i32 s55, s47, 3072
  v_mov_b32 v14, 0x00003f80
  ds_write_b32 v6, v14 offset:13056
  s_waitcnt vmcnt(3)
  v_lshlrev_b32 v12, 16, v12
  v_lshlrev_b32 v8, 16, v8
  v_mul_f32 v13, 0x3fb8aa00, v12
  v_exp_f32 v13, v13
  v_mul_f32 v14, 0x36a407db, v12
  v_fma_f32 v13, v13, v14, v13
  v_mul_f32 v15, 0x3fb8aa00, v8
  v_exp_f32 v15, v15
  v_mul_f32 v16, 0x36a407db, v8
  v_fma_f32 v15, v15, v16, v15
  v_cvt_pk_bf16_f32 v13, v13, v13
  v_lshlrev_b32 v13, 16, v13
  v_cvt_pk_bf16_f32 v15, v15, v15
  v_lshlrev_b32 v15, 16, v15
  s_waitcnt vmcnt(2)
  v_lshlrev_b32 v9, 16, v9
  v_mul_f32 v15, v15, v13
  v_mul_f32 v16, v9, v13
  v_mul_f32 v15, 0xbfb8aa3b, v15
  v_mul_f32 v16, 0x3e22f983, v16
  v_mul_f32 v32, 0x3f800000, v15
  v_mul_f32 v36, 0x3f800000, v16
  v_mul_f32 v33, 0x43800000, v15
  v_mul_f32 v37, 0x43800000, v16
  v_mul_f32 v34, 0x41000000, v15
  v_mul_f32 v38, 0xc1000000, v16
  v_mul_f32 v35, 0x42800000, v15
  v_mul_f32 v39, 0xc2800000, v16
  v_exp_f32 v32, v32
  v_fract_f32 v36, v36
  v_exp_f32 v33, v33
  v_fract_f32 v37, v37
  v_exp_f32 v34, v34
  v_fract_f32 v38, v38
  v_exp_f32 v35, v35
  v_fract_f32 v39, v39
  v_cos_f32 v20, v36
  v_sin_f32 v21, v36
  v_cos_f32 v22, v37
  v_sin_f32 v23, v37
  v_cos_f32 v24, v38
  v_sin_f32 v25, v38
  v_cos_f32 v26, v39
  v_sin_f32 v27, v39
  s_waitcnt vmcnt(0)
  v_lshlrev_b32 v10, 16, v10
  v_lshlrev_b32 v11, 16, v11
  v_add_f32 v13, v13, v13
  v_mul_f32 v20, v32, v20
  v_mul_f32 v21, v32, v21
  v_mul_f32 v22, v33, v22
  v_mul_f32 v23, v33, v23
  v_mul_f32 v24, v34, v24
  v_mul_f32 v25, v34, v25
  v_mul_f32 v26, v35, v26
  v_mul_f32 v27, v35, v27
  v_mul_f32 v28, v10, v13
  v_mul_f32 v29, v11, v13
  v_pk_mul_f32 v[40:41], v[20:21], v[20:21] op_sel:[0,0] op_sel_hi:[1,0]
  v_pk_mul_f32 v[44:45], v[26:27], v[26:27] op_sel:[0,0] op_sel_hi:[1,0]
  v_pk_mul_f32 v[48:49], v[28:29], v[22:23] op_sel:[0,0] op_sel_hi:[1,0]
  v_pk_fma_f32 v[40:41], v[20:21], v[20:21], v[40:41] op_sel:[1,1,0] op_sel_hi:[0,1,1] neg_lo:[1,0,0]
  v_pk_fma_f32 v[44:45], v[26:27], v[26:27], v[44:45] op_sel:[1,1,0] op_sel_hi:[0,1,1] neg_lo:[1,0,0]
  v_pk_fma_f32 v[48:49], v[28:29], v[22:23], v[48:49] op_sel:[1,1,0] op_sel_hi:[0,1,1] neg_lo:[1,0,0]
  v_pk_mul_f32 v[42:43], v[40:41], v[40:41] op_sel:[0,0] op_sel_hi:[1,0]
  v_pk_mul_f32 v[46:47], v[44:45], v[26:27] op_sel:[0,0] op_sel_hi:[1,0]
  v_pk_fma_f32 v[42:43], v[40:41], v[40:41], v[42:43] op_sel:[1,1,0] op_sel_hi:[0,1,1] neg_lo:[1,0,0]
  v_pk_fma_f32 v[46:47], v[44:45], v[26:27], v[46:47] op_sel:[1,1,0] op_sel_hi:[0,1,1] neg_lo:[1,0,0]
  v_pk_mul_f32 v[50:51], v[28:29], v[42:43] op_sel:[0,0] op_sel_hi:[1,0]
  v_pk_fma_f32 v[50:51], v[28:29], v[42:43], v[50:51] op_sel:[1,1,0] op_sel_hi:[0,1,1] neg_lo:[1,0,0]
  v_cvt_pk_bf16_f32 v88, v24, v25
  v_cvt_pk_bf16_f32 v89, v26, v27
  v_cvt_pk_bf16_f32 v90, v44, v45
  v_cvt_pk_bf16_f32 v91, v46, v47
  v_cvt_pk_bf16_f32 v92, v28, v29
  v_cvt_pk_bf16_f32 v93, v50, v51
  v_pk_mul_f32 v[76:77], v[48:49], v[22:23] op_sel:[0,0] op_sel_hi:[1,0]
  ds_write_b32 v6, v88 offset:13600
  ds_write_b32 v6, v89 offset:17408
  ds_write_b32 v6, v90 offset:21760
  ds_write_b32 v6, v91 offset:26112
  ds_write_b32 v6, v92 offset:0
  ds_write_b32 v6, v93 offset:2176
  v_pk_fma_f32 v[76:77], v[48:49], v[22:23], v[76:77] op_sel:[1,1,0] op_sel_hi:[0,1,1] neg_lo:[1,0,0]
  v_pk_mul_f32 v[52:53], v[24:25], v[24:25] op_sel:[0,0] op_sel_hi:[1,0]
  v_pk_mul_f32 v[56:57], v[26:27], v[24:25] op_sel:[0,0] op_sel_hi:[1,0]
  v_pk_mul_f32 v[60:61], v[44:45], v[24:25] op_sel:[0,0] op_sel_hi:[1,0]
  v_pk_mul_f32 v[64:65], v[46:47], v[24:25] op_sel:[0,0] op_sel_hi:[1,0]
  v_pk_mul_f32 v[68:69], v[28:29], v[20:21] op_sel:[0,0] op_sel_hi:[1,0]
  v_pk_mul_f32 v[72:73], v[50:51], v[20:21] op_sel:[0,0] op_sel_hi:[1,0]
  v_cvt_pk_bf16_f32 v94, v76, v77
  v_pk_fma_f32 v[52:53], v[24:25], v[24:25], v[52:53] op_sel:[1,1,0] op_sel_hi:[0,1,1] neg_lo:[1,0,0]
  v_pk_fma_f32 v[56:57], v[26:27], v[24:25], v[56:57] op_sel:[1,1,0] op_sel_hi:[0,1,1] neg_lo:[1,0,0]
  v_pk_fma_f32 v[60:61], v[44:45], v[24:25], v[60:61] op_sel:[1,1,0] op_sel_hi:[0,1,1] neg_lo:[1,0,0]
  v_pk_fma_f32 v[64:65], v[46:47], v[24:25], v[64:65] op_sel:[1,1,0] op_sel_hi:[0,1,1] neg_lo:[1,0,0]
  v_pk_fma_f32 v[68:69], v[28:29], v[20:21], v[68:69] op_sel:[1,1,0] op_sel_hi:[0,1,1] neg_lo:[1,0,0]
  v_pk_fma_f32 v[72:73], v[50:51], v[20:21], v[72:73] op_sel:[1,1,0] op_sel_hi:[0,1,1] neg_lo:[1,0,0]
  ds_write_b32 v6, v94 offset:6528
  v_cvt_pk_bf16_f32 v88, v52, v53
  v_cvt_pk_bf16_f32 v89, v56, v57
  v_cvt_pk_bf16_f32 v90, v60, v61
  v_cvt_pk_bf16_f32 v91, v64, v65
  v_cvt_pk_bf16_f32 v92, v68, v69
  v_cvt_pk_bf16_f32 v93, v72, v73
  v_pk_mul_f32 v[80:81], v[76:77], v[42:43] op_sel:[0,0] op_sel_hi:[1,0]
  ds_write_b32 v6, v88 offset:14144
  ds_write_b32 v6, v89 offset:17952
  ds_write_b32 v6, v90 offset:22304
  ds_write_b32 v6, v91 offset:26656
  ds_write_b32 v6, v92 offset:544
  ds_write_b32 v6, v93 offset:2720
  v_pk_fma_f32 v[80:81], v[76:77], v[42:43], v[80:81] op_sel:[1,1,0] op_sel_hi:[0,1,1] neg_lo:[1,0,0]
  v_pk_mul_f32 v[54:55], v[52:53], v[24:25] op_sel:[0,0] op_sel_hi:[1,0]
  v_pk_mul_f32 v[58:59], v[56:57], v[24:25] op_sel:[0,0] op_sel_hi:[1,0]
  v_pk_mul_f32 v[62:63], v[60:61], v[24:25] op_sel:[0,0] op_sel_hi:[1,0]
  v_pk_mul_f32 v[66:67], v[64:65], v[24:25] op_sel:[0,0] op_sel_hi:[1,0]
  v_pk_mul_f32 v[70:71], v[68:69], v[20:21] op_sel:[0,0] op_sel_hi:[1,0]
  v_pk_mul_f32 v[74:75], v[72:73], v[20:21] op_sel:[0,0] op_sel_hi:[1,0]
  v_cvt_pk_bf16_f32 v95, v80, v81
  v_pk_fma_f32 v[54:55], v[52:53], v[24:25], v[54:55] op_sel:[1,1,0] op_sel_hi:[0,1,1] neg_lo:[1,0,0]
  v_pk_fma_f32 v[58:59], v[56:57], v[24:25], v[58:59] op_sel:[1,1,0] op_sel_hi:[0,1,1] neg_lo:[1,0,0]
  v_pk_fma_f32 v[62:63], v[60:61], v[24:25], v[62:63] op_sel:[1,1,0] op_sel_hi:[0,1,1] neg_lo:[1,0,0]
  v_pk_fma_f32 v[66:67], v[64:65], v[24:25], v[66:67] op_sel:[1,1,0] op_sel_hi:[0,1,1] neg_lo:[1,0,0]
  v_pk_fma_f32 v[70:71], v[68:69], v[20:21], v[70:71] op_sel:[1,1,0] op_sel_hi:[0,1,1] neg_lo:[1,0,0]
  v_pk_fma_f32 v[74:75], v[72:73], v[20:21], v[74:75] op_sel:[1,1,0] op_sel_hi:[0,1,1] neg_lo:[1,0,0]
  ds_write_b32 v6, v95 offset:10880
  v_cvt_pk_bf16_f32 v88, v54, v55
  v_cvt_pk_bf16_f32 v89, v58, v59
  v_cvt_pk_bf16_f32 v90, v62, v63
  v_cvt_pk_bf16_f32 v91, v66, v67
  v_cvt_pk_bf16_f32 v92, v70, v71
  v_cvt_pk_bf16_f32 v93, v74, v75
  v_pk_mul_f32 v[78:79], v[76:77], v[22:23] op_sel:[0,0] op_sel_hi:[1,0]
  ds_write_b32 v6, v88 offset:14688
  ds_write_b32 v6, v89 offset:18496
  ds_write_b32 v6, v90 offset:22848
  ds_write_b32 v6, v91 offset:27200
  ds_write_b32 v6, v92 offset:1088
  ds_write_b32 v6, v93 offset:3264
  v_pk_fma_f32 v[78:79], v[76:77], v[22:23], v[78:79] op_sel:[1,1,0] op_sel_hi:[0,1,1] neg_lo:[1,0,0]
  v_pk_mul_f32 v[52:53], v[54:55], v[24:25] op_sel:[0,0] op_sel_hi:[1,0]
  v_pk_mul_f32 v[56:57], v[58:59], v[24:25] op_sel:[0,0] op_sel_hi:[1,0]
  v_pk_mul_f32 v[60:61], v[62:63], v[24:25] op_sel:[0,0] op_sel_hi:[1,0]
  v_pk_mul_f32 v[64:65], v[66:67], v[24:25] op_sel:[0,0] op_sel_hi:[1,0]
  v_pk_mul_f32 v[68:69], v[70:71], v[20:21] op_sel:[0,0] op_sel_hi:[1,0]
  v_pk_mul_f32 v[72:73], v[74:75], v[20:21] op_sel:[0,0] op_sel_hi:[1,0]
  v_cvt_pk_bf16_f32 v94, v78, v79
  v_pk_fma_f32 v[52:53], v[54:55], v[24:25], v[52:53] op_sel:[1,1,0] op_sel_hi:[0,1,1] neg_lo:[1,0,0]
  v_pk_fma_f32 v[56:57], v[58:59], v[24:25], v[56:57] op_sel:[1,1,0] op_sel_hi:[0,1,1] neg_lo:[1,0,0]
  v_pk_fma_f32 v[60:61], v[62:63], v[24:25], v[60:61] op_sel:[1,1,0] op_sel_hi:[0,1,1] neg_lo:[1,0,0]
  v_pk_fma_f32 v[64:65], v[66:67], v[24:25], v[64:65] op_sel:[1,1,0] op_sel_hi:[0,1,1] neg_lo:[1,0,0]
  v_pk_fma_f32 v[68:69], v[70:71], v[20:21], v[68:69] op_sel:[1,1,0] op_sel_hi:[0,1,1] neg_lo:[1,0,0]
  v_pk_fma_f32 v[72:73], v[74:75], v[20:21], v[72:73] op_sel:[1,1,0] op_sel_hi:[0,1,1] neg_lo:[1,0,0]
  ds_write_b32 v6, v94 offset:7072
  v_cvt_pk_bf16_f32 v88, v52, v53
  v_cvt_pk_bf16_f32 v89, v56, v57
  v_cvt_pk_bf16_f32 v90, v60, v61
  v_cvt_pk_bf16_f32 v91, v64, v65
  v_cvt_pk_bf16_f32 v92, v68, v69
  v_cvt_pk_bf16_f32 v93, v72, v73
  v_pk_mul_f32 v[80:81], v[78:79], v[42:43] op_sel:[0,0] op_sel_hi:[1,0]
  ds_write_b32 v6, v88 offset:15232
  ds_write_b32 v6, v89 offset:19040
  ds_write_b32 v6, v90 offset:23392
  ds_write_b32 v6, v91 offset:27744
  ds_write_b32 v6, v92 offset:1632
  ds_write_b32 v6, v93 offset:3808
  v_pk_fma_f32 v[80:81], v[78:79], v[42:43], v[80:81] op_sel:[1,1,0] op_sel_hi:[0,1,1] neg_lo:[1,0,0]
  v_pk_mul_f32 v[54:55], v[52:53], v[24:25] op_sel:[0,0] op_sel_hi:[1,0]
  v_pk_mul_f32 v[58:59], v[56:57], v[24:25] op_sel:[0,0] op_sel_hi:[1,0]
  v_pk_mul_f32 v[62:63], v[60:61], v[24:25] op_sel:[0,0] op_sel_hi:[1,0]
  v_pk_mul_f32 v[66:67], v[64:65], v[24:25] op_sel:[0,0] op_sel_hi:[1,0]
  v_cvt_pk_bf16_f32 v92, v48, v49
  v_cvt_pk_bf16_f32 v95, v80, v81
  v_pk_fma_f32 v[54:55], v[52:53], v[24:25], v[54:55] op_sel:[1,1,0] op_sel_hi:[0,1,1] neg_lo:[1,0,0]
  v_pk_fma_f32 v[58:59], v[56:57], v[24:25], v[58:59] op_sel:[1,1,0] op_sel_hi:[0,1,1] neg_lo:[1,0,0]
  v_pk_fma_f32 v[62:63], v[60:61], v[24:25], v[62:63] op_sel:[1,1,0] op_sel_hi:[0,1,1] neg_lo:[1,0,0]
  v_pk_fma_f32 v[66:67], v[64:65], v[24:25], v[66:67] op_sel:[1,1,0] op_sel_hi:[0,1,1] neg_lo:[1,0,0]
  ds_write_b32 v6, v92 offset:4352
  ds_write_b32 v6, v95 offset:11424
  v_cvt_pk_bf16_f32 v88, v54, v55
  v_cvt_pk_bf16_f32 v89, v58, v59
  v_cvt_pk_bf16_f32 v90, v62, v63
  v_cvt_pk_bf16_f32 v91, v66, v67
  v_pk_mul_f32 v[68:69], v[48:49], v[40:41] op_sel:[0,0] op_sel_hi:[1,0]
  v_pk_mul_f32 v[76:77], v[78:79], v[22:23] op_sel:[0,0] op_sel_hi:[1,0]
  ds_write_b32 v6, v88 offset:15776
  ds_write_b32 v6, v89 offset:19584
  ds_write_b32 v6, v90 offset:23936
  ds_write_b32 v6, v91 offset:28288
  v_pk_fma_f32 v[68:69], v[48:49], v[40:41], v[68:69] op_sel:[1,1,0] op_sel_hi:[0,1,1] neg_lo:[1,0,0]
  v_pk_fma_f32 v[76:77], v[78:79], v[22:23], v[76:77] op_sel:[1,1,0] op_sel_hi:[0,1,1] neg_lo:[1,0,0]
  v_pk_mul_f32 v[52:53], v[54:55], v[24:25] op_sel:[0,0] op_sel_hi:[1,0]
  v_pk_mul_f32 v[56:57], v[58:59], v[24:25] op_sel:[0,0] op_sel_hi:[1,0]
  v_pk_mul_f32 v[60:61], v[62:63], v[24:25] op_sel:[0,0] op_sel_hi:[1,0]
  v_pk_mul_f32 v[64:65], v[66:67], v[24:25] op_sel:[0,0] op_sel_hi:[1,0]
  v_cvt_pk_bf16_f32 v92, v68, v69
  v_cvt_pk_bf16_f32 v94, v76, v77
  v_pk_fma_f32 v[52:53], v[54:55], v[24:25], v[52:53] op_sel:[1,1,0] op_sel_hi:[0,1,1] neg_lo:[1,0,0]
  v_pk_fma_f32 v[56:57], v[58:59], v[24:25], v[56:57] op_sel:[1,1,0] op_sel_hi:[0,1,1] neg_lo:[1,0,0]
  v_pk_fma_f32 v[60:61], v[62:63], v[24:25], v[60:61] op_sel:[1,1,0] op_sel_hi:[0,1,1] neg_lo:[1,0,0]
  v_pk_fma_f32 v[64:65], v[66:67], v[24:25], v[64:65] op_sel:[1,1,0] op_sel_hi:[0,1,1] neg_lo:[1,0,0]
  ds_write_b32 v6, v92 offset:4896
  ds_write_b32 v6, v94 offset:7616
  v_cvt_pk_bf16_f32 v88, v52, v53
  v_cvt_pk_bf16_f32 v89, v56, v57
  v_cvt_pk_bf16_f32 v90, v60, v61
  v_cvt_pk_bf16_f32 v91, v64, v65
  v_pk_mul_f32 v[70:71], v[68:69], v[40:41] op_sel:[0,0] op_sel_hi:[1,0]
  v_pk_mul_f32 v[78:79], v[76:77], v[22:23] op_sel:[0,0] op_sel_hi:[1,0]
  ds_write_b32 v6, v88 offset:16320
  ds_write_b32 v6, v89 offset:20128
  ds_write_b32 v6, v90 offset:24480
  ds_write_b32 v6, v91 offset:28832
  v_pk_fma_f32 v[70:71], v[68:69], v[40:41], v[70:71] op_sel:[1,1,0] op_sel_hi:[0,1,1] neg_lo:[1,0,0]
  v_pk_fma_f32 v[78:79], v[76:77], v[22:23], v[78:79] op_sel:[1,1,0] op_sel_hi:[0,1,1] neg_lo:[1,0,0]
  v_pk_mul_f32 v[54:55], v[52:53], v[24:25] op_sel:[0,0] op_sel_hi:[1,0]
  v_pk_mul_f32 v[58:59], v[56:57], v[24:25] op_sel:[0,0] op_sel_hi:[1,0]
  v_pk_mul_f32 v[62:63], v[60:61], v[24:25] op_sel:[0,0] op_sel_hi:[1,0]
  v_pk_mul_f32 v[66:67], v[64:65], v[24:25] op_sel:[0,0] op_sel_hi:[1,0]
  v_cvt_pk_bf16_f32 v92, v70, v71
  v_cvt_pk_bf16_f32 v94, v78, v79
  v_pk_fma_f32 v[54:55], v[52:53], v[24:25], v[54:55] op_sel:[1,1,0] op_sel_hi:[0,1,1] neg_lo:[1,0,0]
  v_pk_fma_f32 v[58:59], v[56:57], v[24:25], v[58:59] op_sel:[1,1,0] op_sel_hi:[0,1,1] neg_lo:[1,0,0]
  v_pk_fma_f32 v[62:63], v[60:61], v[24:25], v[62:63] op_sel:[1,1,0] op_sel_hi:[0,1,1] neg_lo:[1,0,0]
  v_pk_fma_f32 v[66:67], v[64:65], v[24:25], v[66:67] op_sel:[1,1,0] op_sel_hi:[0,1,1] neg_lo:[1,0,0]
  ds_write_b32 v6, v92 offset:5440
  ds_write_b32 v6, v94 offset:8160
  v_cvt_pk_bf16_f32 v88, v54, v55
  v_cvt_pk_bf16_f32 v89, v58, v59
  v_cvt_pk_bf16_f32 v90, v62, v63
  v_cvt_pk_bf16_f32 v91, v66, v67
  v_pk_mul_f32 v[68:69], v[70:71], v[40:41] op_sel:[0,0] op_sel_hi:[1,0]
  v_pk_mul_f32 v[76:77], v[78:79], v[22:23] op_sel:[0,0] op_sel_hi:[1,0]
  ds_write_b32 v6, v88 offset:16864
  ds_write_b32 v6, v89 offset:20672
  ds_write_b32 v6, v90 offset:25024
  ds_write_b32 v6, v91 offset:29376
  v_pk_fma_f32 v[68:69], v[70:71], v[40:41], v[68:69] op_sel:[1,1,0] op_sel_hi:[0,1,1] neg_lo:[1,0,0]
  v_pk_fma_f32 v[76:77], v[78:79], v[22:23], v[76:77] op_sel:[1,1,0] op_sel_hi:[0,1,1] neg_lo:[1,0,0]
  v_pk_mul_f32 v[56:57], v[58:59], v[24:25] op_sel:[0,0] op_sel_hi:[1,0]
  v_pk_mul_f32 v[60:61], v[62:63], v[24:25] op_sel:[0,0] op_sel_hi:[1,0]
  v_pk_mul_f32 v[64:65], v[66:67], v[24:25] op_sel:[0,0] op_sel_hi:[1,0]
  v_cvt_pk_bf16_f32 v92, v68, v69
  v_cvt_pk_bf16_f32 v94, v76, v77
  v_pk_fma_f32 v[56:57], v[58:59], v[24:25], v[56:57] op_sel:[1,1,0] op_sel_hi:[0,1,1] neg_lo:[1,0,0]
  v_pk_fma_f32 v[60:61], v[62:63], v[24:25], v[60:61] op_sel:[1,1,0] op_sel_hi:[0,1,1] neg_lo:[1,0,0]
  v_pk_fma_f32 v[64:65], v[66:67], v[24:25], v[64:65] op_sel:[1,1,0] op_sel_hi:[0,1,1] neg_lo:[1,0,0]
  ds_write_b32 v6, v92 offset:5984
  ds_write_b32 v6, v94 offset:8704
  v_cvt_pk_bf16_f32 v89, v56, v57
  v_cvt_pk_bf16_f32 v90, v60, v61
  v_cvt_pk_bf16_f32 v91, v64, v65
  v_pk_mul_f32 v[78:79], v[76:77], v[22:23] op_sel:[0,0] op_sel_hi:[1,0]
  ds_write_b32 v6, v89 offset:21216
  ds_write_b32 v6, v90 offset:25568
  ds_write_b32 v6, v91 offset:29920
  v_pk_fma_f32 v[78:79], v[76:77], v[22:23], v[78:79] op_sel:[1,1,0] op_sel_hi:[0,1,1] neg_lo:[1,0,0]
  v_cvt_pk_bf16_f32 v94, v78, v79
  ds_write_b32 v6, v94 offset:9248
  v_pk_mul_f32 v[76:77], v[78:79], v[22:23] op_sel:[0,0] op_sel_hi:[1,0]
  v_pk_fma_f32 v[76:77], v[78:79], v[22:23], v[76:77] op_sel:[1,1,0] op_sel_hi:[0,1,1] neg_lo:[1,0,0]
  v_cvt_pk_bf16_f32 v94, v76, v77
  ds_write_b32 v6, v94 offset:9792
  s_waitcnt lgkmcnt(0)
  s_barrier
  ds_read_b128 v[132:135], v101 offset:0
  ds_read_b128 v[32:35], v100 offset:13056
  ds_read_b128 v[64:67], v100 offset:21760
  ds_read_b128 v[136:139], v101 offset:64
  ds_read_b128 v[36:39], v100 offset:13120
  ds_read_b128 v[68:71], v100 offset:21824
  ds_read_b128 v[140:143], v101 offset:128
  ds_read_b128 v[40:43], v100 offset:13184
  ds_read_b128 v[72:75], v100 offset:21888
  ds_read_b128 v[144:147], v101 offset:192
  ds_read_b128 v[44:47], v100 offset:13248
  ds_read_b128 v[76:79], v100 offset:21952
  ds_read_b128 v[148:151], v101 offset:256
  ds_read_b128 v[48:51], v100 offset:13312
  ds_read_b128 v[80:83], v100 offset:22016
  ds_read_b128 v[152:155], v101 offset:320
  ds_read_b128 v[52:55], v100 offset:13376
  ds_read_b128 v[84:87], v100 offset:22080
  ds_read_b128 v[156:159], v101 offset:384
  ds_read_b128 v[56:59], v100 offset:13440
  ds_read_b128 v[88:91], v100 offset:22144
  ds_read_b128 v[160:163], v101 offset:448
  ds_read_b128 v[60:63], v100 offset:13504
  ds_read_b128 v[92:95], v100 offset:22208
  s_waitcnt lgkmcnt(15)
  v_mfma_f32_16x16x32_bf16 v[20:23], v[132:135], v[32:35], 0
  v_mfma_f32_16x16x32_bf16 v[24:27], v[132:135], v[64:67], 0
  s_waitcnt lgkmcnt(15)
  v_mfma_f32_16x16x32_bf16 v[20:23], v[136:139], v[36:39], v[20:23]
  v_mfma_f32_16x16x32_bf16 v[24:27], v[136:139], v[68:71], v[24:27]
  s_waitcnt lgkmcnt(15)
  v_mfma_f32_16x16x32_bf16 v[20:23], v[140:143], v[40:43], v[20:23]
  v_mfma_f32_16x16x32_bf16 v[24:27], v[140:143], v[72:75], v[24:27]
  s_waitcnt lgkmcnt(12)
  v_mfma_f32_16x16x32_bf16 v[20:23], v[144:147], v[44:47], v[20:23]
  v_mfma_f32_16x16x32_bf16 v[24:27], v[144:147], v[76:79], v[24:27]
  s_waitcnt lgkmcnt(9)
  v_mfma_f32_16x16x32_bf16 v[20:23], v[148:151], v[48:51], v[20:23]
  v_mfma_f32_16x16x32_bf16 v[24:27], v[148:151], v[80:83], v[24:27]
  s_waitcnt lgkmcnt(6)
  v_mfma_f32_16x16x32_bf16 v[20:23], v[152:155], v[52:55], v[20:23]
  v_mfma_f32_16x16x32_bf16 v[24:27], v[152:155], v[84:87], v[24:27]
  s_waitcnt lgkmcnt(3)
  v_mfma_f32_16x16x32_bf16 v[20:23], v[156:159], v[56:59], v[20:23]
  v_mfma_f32_16x16x32_bf16 v[24:27], v[156:159], v[88:91], v[24:27]
  s_waitcnt lgkmcnt(0)
  v_mfma_f32_16x16x32_bf16 v[20:23], v[160:163], v[60:63], v[20:23]
  v_mfma_f32_16x16x32_bf16 v[24:27], v[160:163], v[92:95], v[24:27]
  s_nop 7
  v_cvt_pk_bf16_f32 v20, v20, v20
  ds_write_b16 v102, v20
  ds_write_b16 v112, v20
  v_cvt_pk_bf16_f32 v21, v21, v21
  ds_write_b16 v103, v21
  ds_write_b16 v113, v21
  v_cvt_pk_bf16_f32 v22, v22, v22
  ds_write_b16 v104, v22
  ds_write_b16 v114, v22
  v_cvt_pk_bf16_f32 v23, v23, v23
  ds_write_b16 v105, v23
  ds_write_b16 v115, v23
  v_cvt_pk_bf16_f32 v24, v24, v24
  ds_write_b16 v106, v24
  ds_write_b16 v116, v24
  v_cvt_pk_bf16_f32 v25, v25, v25
  ds_write_b16 v107, v25
  ds_write_b16 v117, v25
  v_cvt_pk_bf16_f32 v26, v26, v26
  ds_write_b16 v108, v26
  ds_write_b16 v118, v26
  v_cvt_pk_bf16_f32 v27, v27, v27
  ds_write_b16 v109, v27
  ds_write_b16 v119, v27
  s_waitcnt lgkmcnt(0)
  s_barrier
  ds_read_b128 v[32:35], v110
  ds_read_b128 v[36:39], v110 offset:2048
  s_waitcnt lgkmcnt(1)
  buffer_store_dwordx4 v[32:35], v130, s[36:39], s55 offen
  s_cmp_lg_u32 s46, 0
  s_cbranch_scc1 k1_kg_done
  s_waitcnt lgkmcnt(0)
  buffer_store_dwordx4 v[36:39], v130, s[36:39], s55 offen offset:2048
k1_kg_done:
  s_endpgm
k1_ln:
  v_lshlrev_b32 v3, 4, v1
  s_lshr_b32 s45, s2, 3
  s_lshl_b32 s45, s45, 1
  s_sub_u32 s46, s44, 6
  s_add_u32 s45, s45, s46
  s_cmp_lt_u32 s44, 6
  s_cbranch_scc1 k1_no_pf
  s_getpc_b64 s[56:57]
pc_ref1:
  s_add_u32 s56, s56, (k1_kernel - pc_ref1) & 0xffffffff
  s_addc_u32 s57, s57, ((k1_kernel - pc_ref1) >> 32) & 0xffffffff
  s_mov_b32 s58, code_end - k1_kernel
  s_mov_b32 s59, 0x00020000
  s_lshl_b32 s45, s45, 10
  buffer_load_dwordx4 v[76:79], v3, s[56:59], s45 offen
  s_branch k1_pf_done
k1_no_pf:
  s_nop 0
k1_pf_done:
  s_load_dwordx2 s[4:5], s[0:1], 0
  s_load_dwordx2 s[6:7], s[0:1], 104
  s_load_dwordx4 s[48:51], s[0:1], 64
  s_load_dwordx4 s[68:71], s[0:1], 80
  s_load_dwordx2 s[54:55], s[0:1], 48
  s_sub_u32 s22, s44, 4
  s_and_b32 s20, s2, 7
  s_lshr_b32 s21, s2, 3
  s_lshl_b32 s20, s20, 8
  s_lshl_b32 s23, s21, 3
  s_add_u32 s20, s20, s23
  s_lshl_b32 s23, s22, 1
  s_add_u32 s23, s23, s20
  s_lshl_b32 s24, s23, 10
  s_mul_i32 s53, s23, 1152
  v_lshlrev_b32 v3, 4, v1
  s_lshl_b32 s52, s2, 2
  s_add_u32 s52, s52, s22
  s_lshl_b32 s52, s52, 11
  s_mul_i32 s25, s22, 2176
  s_add_u32 s25, s25, 67072
  v_add_u32 v4, s25, v3
  v_and_b32 v5, 15, v1
  v_lshrrev_b32 v6, 2, v5
  v_and_b32 v5, 3, v5
  v_lshrrev_b32 v7, 4, v1
  v_mul_u32_u24 v6, 1088, v6
  v_lshlrev_b32 v5, 3, v5
  v_lshl_add_u32 v5, v7, 5, v5
  v_add_u32 v5, v5, v6
  s_lshl_b32 s26, s22, 8
  s_add_u32 s26, s26, 67072
  v_add_u32 v5, s26, v5
  s_lshl_b32 s27, s22, 7
  v_add_u32 v6, s27, v1
  v_lshlrev_b32 v6, 4, v6
  s_mul_i32 s28, s20, 1040
  s_waitcnt lgkmcnt(0)
  s_mov_b32 s8, s4
  s_mov_b32 s9, s5
  s_mov_b32 s10, 2097152
  s_mov_b32 s11, 0x00020000
  buffer_load_dwordx4 v[8:11], v3, s[8:11], s24 offen offset:0
  buffer_load_dwordx4 v[12:15], v3, s[8:11], s24 offen offset:1024
  s_mov_b32 s56, s48
  s_mov_b32 s57, s49
  s_mov_b32 s58, 1409024
  s_mov_b32 s59, 0x00020000
  s_mov_b32 s60, s50
  s_mov_b32 s61, s51
  s_mov_b32 s62, 1409024
  s_mov_b32 s63, 0x00020000
  s_mov_b32 s64, s68
  s_mov_b32 s65, s69
  s_mov_b32 s66, 1409024
  s_mov_b32 s67, 0x00020000
  v_and_b32 v62, 15, v1
  v_lshlrev_b32 v62, 7, v62
  buffer_load_dword v72, v62, s[56:59], s52 offen
  buffer_load_dword v72, v62, s[60:63], s52 offen
  s_mov_b32 s12, s6
  s_mov_b32 s13, s7
  s_mov_b32 s14, 2359296
  s_mov_b32 s15, 0x00020000
  s_add_u32 s16, s6, 2359296
  s_addc_u32 s17, s7, 0
  s_mov_b32 s18, 2129920
  s_mov_b32 s19, 0x00020000
  s_waitcnt vmcnt(3)
  v_lshlrev_b32 v32, 16, v8
  v_and_b32 v33, 0xffff0000, v8
  v_lshlrev_b32 v34, 16, v9
  v_and_b32 v35, 0xffff0000, v9
  v_lshlrev_b32 v36, 16, v10
  v_and_b32 v37, 0xffff0000, v10
  v_lshlrev_b32 v38, 16, v11
  v_and_b32 v39, 0xffff0000, v11
  v_readfirstlane_b32 s30, v32
  v_pk_add_f32 v[48:49], v[32:33], v[34:35]
  v_pk_add_f32 v[50:51], v[36:37], v[38:39]
  s_mov_b32 s31, s30
  v_pk_add_f32 v[48:49], v[48:49], v[50:51]
  v_pk_add_f32 v[52:53], v[32:33], s[30:31] neg_lo:[0,1] neg_hi:[0,1]
  v_pk_add_f32 v[54:55], v[34:35], s[30:31] neg_lo:[0,1] neg_hi:[0,1]
  v_pk_add_f32 v[56:57], v[36:37], s[30:31] neg_lo:[0,1] neg_hi:[0,1]
  v_pk_add_f32 v[58:59], v[38:39], s[30:31] neg_lo:[0,1] neg_hi:[0,1]
  v_add_f32 v24, v48, v49
  v_pk_mul_f32 v[50:51], v[52:53], v[52:53]
  v_pk_mul_f32 v[48:49], v[54:55], v[54:55]
  v_pk_fma_f32 v[50:51], v[56:57], v[56:57], v[50:51]
  v_pk_fma_f32 v[48:49], v[58:59], v[58:59], v[48:49]
  v_pk_add_f32 v[48:49], v[48:49], v[50:51]
  v_add_f32 v25, v48, v49
  s_waitcnt vmcnt(2)
  v_lshlrev_b32 v40, 16, v12
  v_and_b32 v41, 0xffff0000, v12
  v_lshlrev_b32 v42, 16, v13
  v_and_b32 v43, 0xffff0000, v13
  v_lshlrev_b32 v44, 16, v14
  v_and_b32 v45, 0xffff0000, v14
  v_lshlrev_b32 v46, 16, v15
  v_and_b32 v47, 0xffff0000, v15
  v_readfirstlane_b32 s32, v40
  v_pk_add_f32 v[48:49], v[40:41], v[42:43]
  v_pk_add_f32 v[50:51], v[44:45], v[46:47]
  s_mov_b32 s33, s32
  v_pk_add_f32 v[48:49], v[48:49], v[50:51]
  v_pk_add_f32 v[52:53], v[40:41], s[32:33] neg_lo:[0,1] neg_hi:[0,1]
  v_pk_add_f32 v[54:55], v[42:43], s[32:33] neg_lo:[0,1] neg_hi:[0,1]
  v_pk_add_f32 v[56:57], v[44:45], s[32:33] neg_lo:[0,1] neg_hi:[0,1]
  v_pk_add_f32 v[58:59], v[46:47], s[32:33] neg_lo:[0,1] neg_hi:[0,1]
  v_add_f32 v26, v48, v49
  v_pk_mul_f32 v[50:51], v[52:53], v[52:53]
  v_pk_mul_f32 v[48:49], v[54:55], v[54:55]
  v_pk_fma_f32 v[50:51], v[56:57], v[56:57], v[50:51]
  v_pk_fma_f32 v[48:49], v[58:59], v[58:59], v[48:49]
  v_pk_add_f32 v[48:49], v[48:49], v[50:51]
  v_add_f32 v27, v48, v49
  s_nop 1
  v_add_f32_dpp v24, v24, v24 row_shr:1 row_mask:0xf bank_mask:0xf bound_ctrl:0
  v_add_f32_dpp v25, v25, v25 row_shr:1 row_mask:0xf bank_mask:0xf bound_ctrl:0
  v_add_f32_dpp v26, v26, v26 row_shr:1 row_mask:0xf bank_mask:0xf bound_ctrl:0
  v_add_f32_dpp v27, v27, v27 row_shr:1 row_mask:0xf bank_mask:0xf bound_ctrl:0
  v_add_f32_dpp v24, v24, v24 row_shr:2 row_mask:0xf bank_mask:0xf bound_ctrl:0
  v_add_f32_dpp v25, v25, v25 row_shr:2 row_mask:0xf bank_mask:0xf bound_ctrl:0
  v_add_f32_dpp v26, v26, v26 row_shr:2 row_mask:0xf bank_mask:0xf bound_ctrl:0
  v_add_f32_dpp v27, v27, v27 row_shr:2 row_mask:0xf bank_mask:0xf bound_ctrl:0
  v_add_f32_dpp v24, v24, v24 row_shr:4 row_mask:0xf bank_mask:0xf bound_ctrl:0
  v_add_f32_dpp v25, v25, v25 row_shr:4 row_mask:0xf bank_mask:0xf bound_ctrl:0
  v_add_f32_dpp v26, v26, v26 row_shr:4 row_mask:0xf bank_mask:0xf bound_ctrl:0
  v_add_f32_dpp v27, v27, v27 row_shr:4 row_mask:0xf bank_mask:0xf bound_ctrl:0
  v_add_f32_dpp v24, v24, v24 row_shr:8 row_mask:0xf bank_mask:0xf bound_ctrl:0
  v_add_f32_dpp v25, v25, v25 row_shr:8 row_mask:0xf bank_mask:0xf bound_ctrl:0
  v_add_f32_dpp v26, v26, v26 row_shr:8 row_mask:0xf bank_mask:0xf bound_ctrl:0
  v_add_f32_dpp v27, v27, v27 row_shr:8 row_mask:0xf bank_mask:0xf bound_ctrl:0
  v_add_f32_dpp v24, v24, v24 row_bcast:15 row_mask:0xa bank_mask:0xf
  v_add_f32_dpp v25, v25, v25 row_bcast:15 row_mask:0xa bank_mask:0xf
  v_add_f32_dpp v26, v26, v26 row_bcast:15 row_mask:0xa bank_mask:0xf
  v_add_f32_dpp v27, v27, v27 row_bcast:15 row_mask:0xa bank_mask:0xf
  v_add_f32_dpp v24, v24, v24 row_bcast:31 row_mask:0xc bank_mask:0xf
  v_add_f32_dpp v25, v25, v25 row_bcast:31 row_mask:0xc bank_mask:0xf
  v_add_f32_dpp v26, v26, v26 row_bcast:31 row_mask:0xc bank_mask:0xf
  v_add_f32_dpp v27, v27, v27 row_bcast:31 row_mask:0xc bank_mask:0xf
  s_nop 1
  v_mul_f32 v24, 0x3b000000, v24
  v_mul_f32 v25, 0x3b000000, v25
  v_mul_f32 v26, 0x3b000000, v26
  v_mul_f32 v27, 0x3b000000, v27
  v_subrev_f32 v28, s30, v24
  v_cvt_pk_bf16_f32 v24, v24, v24
  v_lshlrev_b32 v24, 16, v24
  v_subrev_f32 v29, s32, v26
  v_cvt_pk_bf16_f32 v26, v26, v26
  v_lshlrev_b32 v26, 16, v26
  v_fma_f32 v25, -v28, v28, v25
  v_max_f32 v25, 0, v25
  v_fma_f32 v27, -v29, v29, v27
  v_max_f32 v27, 0, v27
  v_cvt_pk_bf16_f32 v25, v25, v25
  v_lshlrev_b32 v25, 16, v25
  v_cvt_pk_bf16_f32 v27, v27, v27
  v_lshlrev_b32 v27, 16, v27
  v_add_f32 v25, 0x3727c5ac, v25
  v_readlane_b32 s36, v24, 63
  v_add_f32 v27, 0x3727c5ac, v27
  v_readlane_b32 s38, v26, 63
  v_cvt_pk_bf16_f32 v25, v25, v25
  v_lshlrev_b32 v25, 16, v25
  v_cvt_pk_bf16_f32 v27, v27, v27
  v_lshlrev_b32 v27, 16, v27
  v_sqrt_f32 v25, v25
  v_sqrt_f32 v27, v27
  s_mov_b32 s37, s36
  s_mov_b32 s39, s38
  v_cvt_pk_bf16_f32 v25, v25, v25
  v_lshlrev_b32 v25, 16, v25
  v_cvt_pk_bf16_f32 v27, v27, v27
  v_lshlrev_b32 v27, 16, v27
  v_rcp_f32 v25, v25
  v_rcp_f32 v27, v27
  v_pk_add_f32 v[32:33], v[32:33], s[36:37] neg_lo:[0,1] neg_hi:[0,1]
  v_pk_add_f32 v[34:35], v[34:35], s[36:37] neg_lo:[0,1] neg_hi:[0,1]
  v_pk_add_f32 v[36:37], v[36:37], s[36:37] neg_lo:[0,1] neg_hi:[0,1]
  v_pk_add_f32 v[38:39], v[38:39], s[36:37] neg_lo:[0,1] neg_hi:[0,1]
  v_pk_add_f32 v[40:41], v[40:41], s[38:39] neg_lo:[0,1] neg_hi:[0,1]
  v_pk_add_f32 v[42:43], v[42:43], s[38:39] neg_lo:[0,1] neg_hi:[0,1]
  v_pk_add_f32 v[44:45], v[44:45], s[38:39] neg_lo:[0,1] neg_hi:[0,1]
  v_pk_add_f32 v[46:47], v[46:47], s[38:39] neg_lo:[0,1] neg_hi:[0,1]
  v_readlane_b32 s40, v25, 63
  v_readlane_b32 s42, v27, 63
  v_cvt_pk_bf16_f32 v8, v32, v33
  v_cvt_pk_bf16_f32 v9, v34, v35
  v_cvt_pk_bf16_f32 v10, v36, v37
  v_cvt_pk_bf16_f32 v11, v38, v39
  v_cvt_pk_bf16_f32 v12, v40, v41
  v_cvt_pk_bf16_f32 v13, v42, v43
  v_cvt_pk_bf16_f32 v14, v44, v45
  v_cvt_pk_bf16_f32 v15, v46, v47
  s_mov_b32 s41, s40
  s_mov_b32 s43, s42
  v_lshlrev_b32 v32, 16, v8
  v_and_b32 v33, 0xffff0000, v8
  v_lshlrev_b32 v34, 16, v9
  v_and_b32 v35, 0xffff0000, v9
  v_lshlrev_b32 v36, 16, v10
  v_and_b32 v37, 0xffff0000, v10
  v_lshlrev_b32 v38, 16, v11
  v_and_b32 v39, 0xffff0000, v11
  v_pk_mul_f32 v[32:33], v[32:33], s[40:41]
  v_pk_mul_f32 v[34:35], v[34:35], s[40:41]
  v_pk_mul_f32 v[36:37], v[36:37], s[40:41]
  v_pk_mul_f32 v[38:39], v[38:39], s[40:41]
  v_cvt_pk_bf16_f32 v16, v32, v33
  v_cvt_pk_bf16_f32 v17, v34, v35
  v_cvt_pk_bf16_f32 v18, v36, v37
  v_cvt_pk_bf16_f32 v19, v38, v39
  ds_write_b128 v4, v[16:19] offset:0
  buffer_store_dwordx4 v[16:19], v3, s[12:15], s53 offen offset:0 sc1
  v_lshlrev_b32 v40, 16, v12
  v_and_b32 v41, 0xffff0000, v12
  v_lshlrev_b32 v42, 16, v13
  v_and_b32 v43, 0xffff0000, v13
  v_lshlrev_b32 v44, 16, v14
  v_and_b32 v45, 0xffff0000, v14
  v_lshlrev_b32 v46, 16, v15
  v_and_b32 v47, 0xffff0000, v15
  v_pk_mul_f32 v[40:41], v[40:41], s[42:43]
  v_pk_mul_f32 v[42:43], v[42:43], s[42:43]
  v_pk_mul_f32 v[44:45], v[44:45], s[42:43]
  v_pk_mul_f32 v[46:47], v[46:47], s[42:43]
  v_cvt_pk_bf16_f32 v20, v40, v41
  v_cvt_pk_bf16_f32 v21, v42, v43
  v_cvt_pk_bf16_f32 v22, v44, v45
  v_cvt_pk_bf16_f32 v23, v46, v47
  ds_write_b128 v4, v[20:23] offset:1088
  buffer_store_dwordx4 v[20:23], v3, s[12:15], s53 offen offset:1152 sc1
  s_waitcnt lgkmcnt(0)
  s_barrier
  ds_read_b64_tr_b16 v[32:33], v5 offset:0
  ds_read_b64_tr_b16 v[34:35], v5 offset:4352
  ds_read_b64_tr_b16 v[36:37], v5 offset:128
  ds_read_b64_tr_b16 v[38:39], v5 offset:4480
  s_waitcnt lgkmcnt(2)
  buffer_store_dwordx4 v[32:35], v6, s[16:19], s28 offen sc1
  s_waitcnt lgkmcnt(0)
  buffer_store_dwordx4 v[36:39], v6, s[16:19], s28 offen offset:1024 sc1
  s_endpgm
k1_exit:
  s_endpgm
.p2align 8
k2_kernel:
  s_cmp_ge_u32 s2, 256
  s_cbranch_scc1 k2_exit
  s_cmp_ge_u32 s2, 240
  s_cbranch_scc1 k2_relayout
  s_cmp_ge_u32 s2, 176
  s_cbranch_scc1 k2_conv
  s_load_dwordx4 s[4:7], s[0:1], 64
  s_load_dwordx2 s[8:9], s[0:1], 104
  v_and_b32 v1, 63, v0
  v_lshrrev_b32 v2, 6, v0
  s_lshr_b32 s29, s2, 3
  s_and_b32 s28, s2, 6
  s_and_b32 s31, s29, 1
  s_add_u32 s28, s28, s31
  s_lshr_b32 s29, s29, 1
  s_and_b32 s31, s2, 1
  s_mul_i32 s31, s31, 11
  s_add_u32 s29, s29, s31
  v_readfirstlane_b32 s30, v2
  s_cmp_lt_u32 s30, 4
  s_cbranch_scc1 k2_g1_compute
  s_sub_u32 s30, s30, 4
  v_lshrrev_b32 v3, 3, v1
  v_and_b32 v4, 7, v1
  v_lshrrev_b32 v5, 4, v1
  v_mul_u32_u24 v14, 1152, v3
  v_add_u32 v6, 0, v5
  v_and_b32 v6, 7, v6
  v_xor_b32 v6, v6, v4
  v_lshl_add_u32 v6, v6, 4, v14
  v_add_u32 v8, 0, v6
  v_add_u32 v6, 4, v5
  v_and_b32 v6, 7, v6
  v_xor_b32 v6, v6, v4
  v_lshl_add_u32 v6, v6, 4, v14
  v_add_u32 v9, 8192, v6
  v_add_u32 v6, 8, v5
  v_and_b32 v6, 7, v6
  v_xor_b32 v6, v6, v4
  v_lshl_add_u32 v6, v6, 4, v14
  v_add_u32 v10, 16384, v6
  v_add_u32 v6, 12, v5
  v_and_b32 v6, 7, v6
  v_xor_b32 v6, v6, v4
  v_lshl_add_u32 v6, v6, 4, v14
  v_add_u32 v11, 24576, v6
  v_and_b32 v6, 1, v5
  v_lshrrev_b32 v7, 2, v4
  v_xor_b32 v6, v6, v7
  v_and_b32 v7, 3, v4
  v_lshlrev_b32 v7, 3, v7
  v_lshl_add_u32 v6, v6, 5, v7
  s_lshl_b32 s31, s29, 6
  v_add_u32 v6, s31, v6
  v_mul_u32_u24 v12, 2752, v3
  v_lshl_add_u32 v12, v6, 1, v12
  v_add_u32 v13, 20992, v12
  v_cmp_le_u32 vcc, 1376, v6
  v_mov_b32 v7, 0x40000000
  s_mul_i32 s32, s28, 294912
  v_cndmask_b32 v12, v12, v7, vcc
  v_cndmask_b32 v13, v13, v7, vcc
  s_mul_i32 s33, s30, 73728
  s_add_u32 s32, s32, s33
  s_add_u32 s36, s32, 36864
  s_mul_i32 s33, s30, 44032
  s_lshl_b32 s34, s30, 13
  s_lshl_b32 s35, s30, 11
  s_add_u32 s35, s35, 32768
  s_waitcnt lgkmcnt(0)
  s_mov_b32 s16, s4
  s_mov_b32 s17, s5
  s_mov_b32 s18, 1409024
  s_mov_b32 s19, 0x00020000
  s_mov_b32 s20, s6
  s_mov_b32 s21, s7
  s_mov_b32 s22, 1409024
  s_mov_b32 s23, 0x00020000
  s_mov_b32 s12, s8
  s_mov_b32 s13, s9
  s_mov_b32 s14, 2359296
  s_mov_b32 s15, 0x00020000
  s_add_u32 m0, s35, 0
  s_nop 0
  buffer_load_dwordx4 v12, s[16:19], s33 offen lds
  buffer_load_dwordx4 v13, s[16:19], s33 offen offset:1024 lds
  s_add_u32 m0, s35, 8192
  s_nop 0
  buffer_load_dwordx4 v12, s[20:23], s33 offen lds
  buffer_load_dwordx4 v13, s[20:23], s33 offen offset:1024 lds
  s_add_u32 s33, s33, 176128
  s_add_u32 m0, s34, 0
  s_nop 0
  buffer_load_dwordx4 v8, s[12:15], s32 offen offset:0 lds
  buffer_load_dwordx4 v9, s[12:15], s32 offen offset:1024 lds
  buffer_load_dwordx4 v10, s[12:15], s32 offen offset:2048 lds
  buffer_load_dwordx4 v11, s[12:15], s32 offen offset:3072 lds
  s_add_u32 m0, s34, 4096
  s_add_u32 s32, s32, 128
  buffer_load_dwordx4 v8, s[12:15], s36 offen offset:0 lds
  buffer_load_dwordx4 v9, s[12:15], s36 offen offset:1024 lds
  buffer_load_dwordx4 v10, s[12:15], s36 offen offset:2048 lds
  buffer_load_dwordx4 v11, s[12:15], s36 offen offset:3072 lds
  s_add_u32 s36, s36, 128
  s_add_u32 m0, s35, 49152
  s_nop 0
  buffer_load_dwordx4 v12, s[16:19], s33 offen lds
  buffer_load_dwordx4 v13, s[16:19], s33 offen offset:1024 lds
  s_add_u32 m0, s35, 57344
  s_nop 0
  buffer_load_dwordx4 v12, s[20:23], s33 offen lds
  buffer_load_dwordx4 v13, s[20:23], s33 offen offset:1024 lds
  s_add_u32 s33, s33, 176128
  s_waitcnt vmcnt(4)
  s_barrier
  s_add_u32 m0, s34, 49152
  s_nop 0
  buffer_load_dwordx4 v8, s[12:15], s32 offen offset:0 lds
  buffer_load_dwordx4 v9, s[12:15], s32 offen offset:1024 lds
  buffer_load_dwordx4 v10, s[12:15], s32 offen offset:2048 lds
  buffer_load_dwordx4 v11, s[12:15], s32 offen offset:3072 lds
  s_add_u32 m0, s34, 53248
  s_add_u32 s32, s32, 128
  buffer_load_dwordx4 v8, s[12:15], s36 offen offset:0 lds
  buffer_load_dwordx4 v9, s[12:15], s36 offen offset:1024 lds
  buffer_load_dwordx4 v10, s[12:15], s36 offen offset:2048 lds
  buffer_load_dwordx4 v11, s[12:15], s36 offen offset:3072 lds
  s_add_u32 s36, s36, 128
  s_add_u32 m0, s35, 98304
  s_nop 0
  buffer_load_dwordx4 v12, s[16:19], s33 offen lds
  buffer_load_dwordx4 v13, s[16:19], s33 offen offset:1024 lds
  s_add_u32 m0, s35, 106496
  s_nop 0
  buffer_load_dwordx4 v12, s[20:23], s33 offen lds
  buffer_load_dwordx4 v13, s[20:23], s33 offen offset:1024 lds
  s_add_u32 s33, s33, 176128
  s_add_u32 m0, s34, 98304
  s_nop 0
  buffer_load_dwordx4 v8, s[12:15], s32 offen offset:0 lds
  buffer_load_dwordx4 v9, s[12:15], s32 offen offset:1024 lds
  buffer_load_dwordx4 v10, s[12:15], s32 offen offset:2048 lds
  buffer_load_dwordx4 v11, s[12:15], s32 offen offset:3072 lds
  s_add_u32 m0, s34, 102400
  s_add_u32 s32, s32, 128
  buffer_load_dwordx4 v8, s[12:15], s36 offen offset:0 lds
  buffer_load_dwordx4 v9, s[12:15], s36 offen offset:1024 lds
  buffer_load_dwordx4 v10, s[12:15], s36 offen offset:2048 lds
  buffer_load_dwordx4 v11, s[12:15], s36 offen offset:3072 lds
  s_add_u32 s36, s36, 128
  s_waitcnt vmcnt(12)
  s_barrier
  s_add_u32 m0, s35, 0
  s_nop 0
  buffer_load_dwordx4 v12, s[16:19], s33 offen lds
  buffer_load_dwordx4 v13, s[16:19], s33 offen offset:1024 lds
  s_add_u32 m0, s35, 8192
  s_nop 0
  buffer_load_dwordx4 v12, s[20:23], s33 offen lds
  buffer_load_dwordx4 v13, s[20:23], s33 offen offset:1024 lds
  s_add_u32 s33, s33, 176128
  s_add_u32 m0, s34, 0
  s_nop 0
  buffer_load_dwordx4 v8, s[12:15], s32 offen offset:0 lds
  buffer_load_dwordx4 v9, s[12:15], s32 offen offset:1024 lds
  buffer_load_dwordx4 v10, s[12:15], s32 offen offset:2048 lds
  buffer_load_dwordx4 v11, s[12:15], s32 offen offset:3072 lds
  s_add_u32 m0, s34, 4096
  s_add_u32 s32, s32, 128
  buffer_load_dwordx4 v8, s[12:15], s36 offen offset:0 lds
  buffer_load_dwordx4 v9, s[12:15], s36 offen offset:1024 lds
  buffer_load_dwordx4 v10, s[12:15], s36 offen offset:2048 lds
  buffer_load_dwordx4 v11, s[12:15], s36 offen offset:3072 lds
  s_add_u32 s36, s36, 128
  s_waitcnt vmcnt(12)
  s_barrier
  s_add_u32 m0, s35, 49152
  s_nop 0
  buffer_load_dwordx4 v12, s[16:19], s33 offen lds
  buffer_load_dwordx4 v13, s[16:19], s33 offen offset:1024 lds
  s_add_u32 m0, s35, 57344
  s_nop 0
  buffer_load_dwordx4 v12, s[20:23], s33 offen lds
  buffer_load_dwordx4 v13, s[20:23], s33 offen offset:1024 lds
  s_add_u32 s33, s33, 176128
  s_add_u32 m0, s34, 49152
  s_nop 0
  buffer_load_dwordx4 v8, s[12:15], s32 offen offset:0 lds
  buffer_load_dwordx4 v9, s[12:15], s32 offen offset:1024 lds
  buffer_load_dwordx4 v10, s[12:15], s32 offen offset:2048 lds
  buffer_load_dwordx4 v11, s[12:15], s32 offen offset:3072 lds
  s_add_u32 m0, s34, 53248
  s_add_u32 s32, s32, 128
  buffer_load_dwordx4 v8, s[12:15], s36 offen offset:0 lds
  buffer_load_dwordx4 v9, s[12:15], s36 offen offset:1024 lds
  buffer_load_dwordx4 v10, s[12:15], s36 offen offset:2048 lds
  buffer_load_dwordx4 v11, s[12:15], s36 offen offset:3072 lds
  s_add_u32 s36, s36, 128
  s_waitcnt vmcnt(12)
  s_barrier
  s_add_u32 m0, s35, 98304
  s_nop 0
  buffer_load_dwordx4 v12, s[16:19], s33 offen lds
  buffer_load_dwordx4 v13, s[16:19], s33 offen offset:1024 lds
  s_add_u32 m0, s35, 106496
  s_nop 0
  buffer_load_dwordx4 v12, s[20:23], s33 offen lds
  buffer_load_dwordx4 v13, s[20:23], s33 offen offset:1024 lds
  s_add_u32 s33, s33, 176128
  s_add_u32 m0, s34, 98304
  s_nop 0
  buffer_load_dwordx4 v8, s[12:15], s32 offen offset:0 lds
  buffer_load_dwordx4 v9, s[12:15], s32 offen offset:1024 lds
  buffer_load_dwordx4 v10, s[12:15], s32 offen offset:2048 lds
  buffer_load_dwordx4 v11, s[12:15], s32 offen offset:3072 lds
  s_add_u32 m0, s34, 102400
  s_add_u32 s32, s32, 128
  buffer_load_dwordx4 v8, s[12:15], s36 offen offset:0 lds
  buffer_load_dwordx4 v9, s[12:15], s36 offen offset:1024 lds
  buffer_load_dwordx4 v10, s[12:15], s36 offen offset:2048 lds
  buffer_load_dwordx4 v11, s[12:15], s36 offen offset:3072 lds
  s_add_u32 s36, s36, 128
  s_waitcnt vmcnt(12)
  s_barrier
  s_add_u32 m0, s35, 0
  s_nop 0
  buffer_load_dwordx4 v12, s[16:19], s33 offen lds
  buffer_load_dwordx4 v13, s[16:19], s33 offen offset:1024 lds
  s_add_u32 m0, s35, 8192
  s_nop 0
  buffer_load_dwordx4 v12, s[20:23], s33 offen lds
  buffer_load_dwordx4 v13, s[20:23], s33 offen offset:1024 lds
  s_add_u32 s33, s33, 176128
  s_add_u32 m0, s34, 0
  s_nop 0
  buffer_load_dwordx4 v8, s[12:15], s32 offen offset:0 lds
  buffer_load_dwordx4 v9, s[12:15], s32 offen offset:1024 lds
  buffer_load_dwordx4 v10, s[12:15], s32 offen offset:2048 lds
  buffer_load_dwordx4 v11, s[12:15], s32 offen offset:3072 lds
  s_add_u32 m0, s34, 4096
  s_add_u32 s32, s32, 128
  buffer_load_dwordx4 v8, s[12:15], s36 offen offset:0 lds
  buffer_load_dwordx4 v9, s[12:15], s36 offen offset:1024 lds
  buffer_load_dwordx4 v10, s[12:15], s36 offen offset:2048 lds
  buffer_load_dwordx4 v11, s[12:15], s36 offen offset:3072 lds
  s_add_u32 s36, s36, 128
  s_waitcnt vmcnt(12)
  s_barrier
  s_add_u32 m0, s35, 49152
  s_nop 0
  buffer_load_dwordx4 v12, s[16:19], s33 offen lds
  buffer_load_dwordx4 v13, s[16:19], s33 offen offset:1024 lds
  s_add_u32 m0, s35, 57344
  s_nop 0
  buffer_load_dwordx4 v12, s[20:23], s33 offen lds
  buffer_load_dwordx4 v13, s[20:23], s33 offen offset:1024 lds
  s_add_u32 s33, s33, 176128
  s_add_u32 m0, s34, 49152
  s_nop 0
  buffer_load_dwordx4 v8, s[12:15], s32 offen offset:0 lds
  buffer_load_dwordx4 v9, s[12:15], s32 offen offset:1024 lds
  buffer_load_dwordx4 v10, s[12:15], s32 offen offset:2048 lds
  buffer_load_dwordx4 v11, s[12:15], s32 offen offset:3072 lds
  s_add_u32 m0, s34, 53248
  s_add_u32 s32, s32, 128
  buffer_load_dwordx4 v8, s[12:15], s36 offen offset:0 lds
  buffer_load_dwordx4 v9, s[12:15], s36 offen offset:1024 lds
  buffer_load_dwordx4 v10, s[12:15], s36 offen offset:2048 lds
  buffer_load_dwordx4 v11, s[12:15], s36 offen offset:3072 lds
  s_add_u32 s36, s36, 128
  s_waitcnt vmcnt(12)
  s_barrier
  s_waitcnt vmcnt(0)
  s_barrier
  s_endpgm
k2_g1_compute:
  v_and_b32 v3, 31, v1
  v_lshrrev_b32 v4, 5, v1
  v_lshrrev_b32 v5, 1, v3
  v_and_b32 v5, 7, v5
  v_xor_b32 v5, v5, v4
  v_lshlrev_b32 v6, 7, v3
  s_lshl_b32 s38, s30, 13
  v_add_u32 v6, s38, v6
  v_xor_b32 v7, 0, v5
  v_lshl_add_u32 v16, v7, 4, v6
  v_xor_b32 v7, 2, v5
  v_lshl_add_u32 v17, v7, 4, v6
  v_xor_b32 v7, 4, v5
  v_lshl_add_u32 v18, v7, 4, v6
  v_xor_b32 v7, 6, v5
  v_lshl_add_u32 v19, v7, 4, v6
  v_and_b32 v5, 15, v1
  v_lshrrev_b32 v6, 2, v5
  v_and_b32 v5, 3, v5
  v_lshrrev_b32 v7, 4, v1
  v_and_b32 v7, 1, v7
  v_and_b32 v13, 1, v5
  v_lshlrev_b32 v13, 5, v13
  v_lshl_add_u32 v13, v7, 4, v13
  v_lshrrev_b32 v5, 1, v5
  v_lshl_add_u32 v13, v5, 3, v13
  v_lshrrev_b32 v5, 1, v6
  v_lshl_add_u32 v13, v5, 6, v13
  v_lshl_add_u32 v6, v4, 3, v6
  v_lshl_add_u32 v13, v6, 7, v13
  v_add_u32 v20, 32768, v13
  v_xor_b32 v21, 64, v20
  v_mov_b32 v12, 0
  s_mul_i32 s39, s30, 9216
  v_mul_u32_u24 v22, 144, v3
  v_lshl_add_u32 v22, v4, 5, v22
  v_add_u32 v22, s39, v22
  v_lshrrev_b32 v5, 3, v1
  v_and_b32 v6, 7, v1
  v_mul_u32_u24 v23, 144, v5
  v_lshl_add_u32 v23, v6, 4, v23
  v_add_u32 v23, s39, v23
  v_mul_u32_u24 v14, 2944, v5
  v_lshl_add_u32 v14, v6, 4, v14
  s_lshl_b32 s40, s28, 8
  s_lshl_b32 s41, s30, 6
  s_add_u32 s40, s40, s41
  s_mul_i32 s42, s40, 2944
  s_lshl_b32 s43, s29, 7
  s_add_u32 s42, s42, s43
  s_waitcnt lgkmcnt(0)
  s_add_u32 s24, s8, 8912896
  s_addc_u32 s25, s9, 0
  s_mov_b32 s26, 6029312
  s_mov_b32 s27, 0x00020000
  s_waitcnt lgkmcnt(0)
  s_barrier
  ds_read_b64_tr_b16 v[32:33], v20 offset:0
  ds_read_b64_tr_b16 v[34:35], v20 offset:512
  ds_read_b64_tr_b16 v[36:37], v21 offset:0
  ds_read_b64_tr_b16 v[38:39], v21 offset:512
  ds_read_b128 v[48:51], v16 offset:0
  ds_read_b64_tr_b16 v[40:41], v20 offset:8192
  ds_read_b64_tr_b16 v[42:43], v20 offset:8704
  ds_read_b64_tr_b16 v[44:45], v21 offset:8192
  ds_read_b64_tr_b16 v[46:47], v21 offset:8704
  ds_read_b128 v[52:55], v16 offset:4096
  s_waitcnt lgkmcnt(0)
  v_mfma_f32_32x32x16_bf16 v[128:143], v[32:35], v[48:51], 0
  ds_read_b64_tr_b16 v[56:57], v20 offset:2048
  ds_read_b64_tr_b16 v[58:59], v20 offset:2560
  ds_read_b64_tr_b16 v[60:61], v21 offset:2048
  v_mfma_f32_32x32x16_bf16 v[160:175], v[36:39], v[48:51], 0
  ds_read_b64_tr_b16 v[62:63], v21 offset:2560
  ds_read_b128 v[72:75], v17 offset:0
  ds_read_b64_tr_b16 v[64:65], v20 offset:10240
  v_mfma_f32_32x32x16_bf16 v[192:207], v[40:43], v[48:51], 0
  ds_read_b64_tr_b16 v[66:67], v20 offset:10752
  ds_read_b64_tr_b16 v[68:69], v21 offset:10240
  v_mfma_f32_32x32x16_bf16 v[224:239], v[44:47], v[48:51], 0
  ds_read_b64_tr_b16 v[70:71], v21 offset:10752
  ds_read_b128 v[76:79], v17 offset:4096
  v_mfma_f32_32x32x16_bf16 v[144:159], v[32:35], v[52:55], 0
  v_mfma_f32_32x32x16_bf16 v[176:191], v[36:39], v[52:55], 0
  v_mfma_f32_32x32x16_bf16 v[208:223], v[40:43], v[52:55], 0
  v_mfma_f32_32x32x16_bf16 v[240:255], v[44:47], v[52:55], 0
  s_waitcnt lgkmcnt(0)
  v_mfma_f32_32x32x16_bf16 v[128:143], v[56:59], v[72:75], v[128:143]
  ds_read_b64_tr_b16 v[32:33], v20 offset:4096
  ds_read_b64_tr_b16 v[34:35], v20 offset:4608
  ds_read_b64_tr_b16 v[36:37], v21 offset:4096
  v_mfma_f32_32x32x16_bf16 v[160:175], v[60:63], v[72:75], v[160:175]
  ds_read_b64_tr_b16 v[38:39], v21 offset:4608
  ds_read_b128 v[48:51], v18 offset:0
  ds_read_b64_tr_b16 v[40:41], v20 offset:12288
  v_mfma_f32_32x32x16_bf16 v[192:207], v[64:67], v[72:75], v[192:207]
  ds_read_b64_tr_b16 v[42:43], v20 offset:12800
  ds_read_b64_tr_b16 v[44:45], v21 offset:12288
  v_mfma_f32_32x32x16_bf16 v[224:239], v[68:71], v[72:75], v[224:239]
  ds_read_b64_tr_b16 v[46:47], v21 offset:12800
  ds_read_b128 v[52:55], v18 offset:4096
  v_mfma_f32_32x32x16_bf16 v[144:159], v[56:59], v[76:79], v[144:159]
  v_mfma_f32_32x32x16_bf16 v[176:191], v[60:63], v[76:79], v[176:191]
  v_mfma_f32_32x32x16_bf16 v[208:223], v[64:67], v[76:79], v[208:223]
  v_mfma_f32_32x32x16_bf16 v[240:255], v[68:71], v[76:79], v[240:255]
  s_waitcnt lgkmcnt(0)
  v_mfma_f32_32x32x16_bf16 v[128:143], v[32:35], v[48:51], v[128:143]
  ds_read_b64_tr_b16 v[56:57], v20 offset:6144
  ds_read_b64_tr_b16 v[58:59], v20 offset:6656
  ds_read_b64_tr_b16 v[60:61], v21 offset:6144
  v_mfma_f32_32x32x16_bf16 v[160:175], v[36:39], v[48:51], v[160:175]
  ds_read_b64_tr_b16 v[62:63], v21 offset:6656
  ds_read_b128 v[72:75], v19 offset:0
  ds_read_b64_tr_b16 v[64:65], v20 offset:14336
  v_mfma_f32_32x32x16_bf16 v[192:207], v[40:43], v[48:51], v[192:207]
  ds_read_b64_tr_b16 v[66:67], v20 offset:14848
  ds_read_b64_tr_b16 v[68:69], v21 offset:14336
  v_mfma_f32_32x32x16_bf16 v[224:239], v[44:47], v[48:51], v[224:239]
  ds_read_b64_tr_b16 v[70:71], v21 offset:14848
  ds_read_b128 v[76:79], v19 offset:4096
  v_mfma_f32_32x32x16_bf16 v[144:159], v[32:35], v[52:55], v[144:159]
  v_mfma_f32_32x32x16_bf16 v[176:191], v[36:39], v[52:55], v[176:191]
  v_mfma_f32_32x32x16_bf16 v[208:223], v[40:43], v[52:55], v[208:223]
  v_mfma_f32_32x32x16_bf16 v[240:255], v[44:47], v[52:55], v[240:255]
  s_waitcnt lgkmcnt(0)
  s_barrier
  v_add_u32 v16, 0xc000, v16
  v_add_u32 v17, 0xc000, v17
  v_add_u32 v18, 0xc000, v18
  v_add_u32 v19, 0xc000, v19
  v_add_u32 v20, 0xc000, v20
  v_add_u32 v21, 0xc000, v21
  v_mfma_f32_32x32x16_bf16 v[128:143], v[56:59], v[72:75], v[128:143]
  ds_read_b64_tr_b16 v[32:33], v20 offset:0
  ds_read_b64_tr_b16 v[34:35], v20 offset:512
  ds_read_b64_tr_b16 v[36:37], v21 offset:0
  v_mfma_f32_32x32x16_bf16 v[160:175], v[60:63], v[72:75], v[160:175]
  ds_read_b64_tr_b16 v[38:39], v21 offset:512
  ds_read_b128 v[48:51], v16 offset:0
  ds_read_b64_tr_b16 v[40:41], v20 offset:8192
  v_mfma_f32_32x32x16_bf16 v[192:207], v[64:67], v[72:75], v[192:207]
  ds_read_b64_tr_b16 v[42:43], v20 offset:8704
  ds_read_b64_tr_b16 v[44:45], v21 offset:8192
  v_mfma_f32_32x32x16_bf16 v[224:239], v[68:71], v[72:75], v[224:239]
  ds_read_b64_tr_b16 v[46:47], v21 offset:8704
  ds_read_b128 v[52:55], v16 offset:4096
  v_mfma_f32_32x32x16_bf16 v[144:159], v[56:59], v[76:79], v[144:159]
  v_mfma_f32_32x32x16_bf16 v[176:191], v[60:63], v[76:79], v[176:191]
  v_mfma_f32_32x32x16_bf16 v[208:223], v[64:67], v[76:79], v[208:223]
  v_mfma_f32_32x32x16_bf16 v[240:255], v[68:71], v[76:79], v[240:255]
  s_waitcnt lgkmcnt(0)
  v_mfma_f32_32x32x16_bf16 v[128:143], v[32:35], v[48:51], v[128:143]
  ds_read_b64_tr_b16 v[56:57], v20 offset:2048
  ds_read_b64_tr_b16 v[58:59], v20 offset:2560
  ds_read_b64_tr_b16 v[60:61], v21 offset:2048
  v_mfma_f32_32x32x16_bf16 v[160:175], v[36:39], v[48:51], v[160:175]
  ds_read_b64_tr_b16 v[62:63], v21 offset:2560
  ds_read_b128 v[72:75], v17 offset:0
  ds_read_b64_tr_b16 v[64:65], v20 offset:10240
  v_mfma_f32_32x32x16_bf16 v[192:207], v[40:43], v[48:51], v[192:207]
  ds_read_b64_tr_b16 v[66:67], v20 offset:10752
  ds_read_b64_tr_b16 v[68:69], v21 offset:10240
  v_mfma_f32_32x32x16_bf16 v[224:239], v[44:47], v[48:51], v[224:239]
  ds_read_b64_tr_b16 v[70:71], v21 offset:10752
  ds_read_b128 v[76:79], v17 offset:4096
  v_mfma_f32_32x32x16_bf16 v[144:159], v[32:35], v[52:55], v[144:159]
  v_mfma_f32_32x32x16_bf16 v[176:191], v[36:39], v[52:55], v[176:191]
  v_mfma_f32_32x32x16_bf16 v[208:223], v[40:43], v[52:55], v[208:223]
  v_mfma_f32_32x32x16_bf16 v[240:255], v[44:47], v[52:55], v[240:255]
  s_waitcnt lgkmcnt(0)
  v_mfma_f32_32x32x16_bf16 v[128:143], v[56:59], v[72:75], v[128:143]
  ds_read_b64_tr_b16 v[32:33], v20 offset:4096
  ds_read_b64_tr_b16 v[34:35], v20 offset:4608
  ds_read_b64_tr_b16 v[36:37], v21 offset:4096
  v_mfma_f32_32x32x16_bf16 v[160:175], v[60:63], v[72:75], v[160:175]
  ds_read_b64_tr_b16 v[38:39], v21 offset:4608
  ds_read_b128 v[48:51], v18 offset:0
  ds_read_b64_tr_b16 v[40:41], v20 offset:12288
  v_mfma_f32_32x32x16_bf16 v[192:207], v[64:67], v[72:75], v[192:207]
  ds_read_b64_tr_b16 v[42:43], v20 offset:12800
  ds_read_b64_tr_b16 v[44:45], v21 offset:12288
  v_mfma_f32_32x32x16_bf16 v[224:239], v[68:71], v[72:75], v[224:239]
  ds_read_b64_tr_b16 v[46:47], v21 offset:12800
  ds_read_b128 v[52:55], v18 offset:4096
  v_mfma_f32_32x32x16_bf16 v[144:159], v[56:59], v[76:79], v[144:159]
  v_mfma_f32_32x32x16_bf16 v[176:191], v[60:63], v[76:79], v[176:191]
  v_mfma_f32_32x32x16_bf16 v[208:223], v[64:67], v[76:79], v[208:223]
  v_mfma_f32_32x32x16_bf16 v[240:255], v[68:71], v[76:79], v[240:255]
  s_waitcnt lgkmcnt(0)
  v_mfma_f32_32x32x16_bf16 v[128:143], v[32:35], v[48:51], v[128:143]
  ds_read_b64_tr_b16 v[56:57], v20 offset:6144
  ds_read_b64_tr_b16 v[58:59], v20 offset:6656
  ds_read_b64_tr_b16 v[60:61], v21 offset:6144
  v_mfma_f32_32x32x16_bf16 v[160:175], v[36:39], v[48:51], v[160:175]
  ds_read_b64_tr_b16 v[62:63], v21 offset:6656
  ds_read_b128 v[72:75], v19 offset:0
  ds_read_b64_tr_b16 v[64:65], v20 offset:14336
  v_mfma_f32_32x32x16_bf16 v[192:207], v[40:43], v[48:51], v[192:207]
  ds_read_b64_tr_b16 v[66:67], v20 offset:14848
  ds_read_b64_tr_b16 v[68:69], v21 offset:14336
  v_mfma_f32_32x32x16_bf16 v[224:239], v[44:47], v[48:51], v[224:239]
  ds_read_b64_tr_b16 v[70:71], v21 offset:14848
  ds_read_b128 v[76:79], v19 offset:4096
  v_mfma_f32_32x32x16_bf16 v[144:159], v[32:35], v[52:55], v[144:159]
  v_mfma_f32_32x32x16_bf16 v[176:191], v[36:39], v[52:55], v[176:191]
  v_mfma_f32_32x32x16_bf16 v[208:223], v[40:43], v[52:55], v[208:223]
  v_mfma_f32_32x32x16_bf16 v[240:255], v[44:47], v[52:55], v[240:255]
  s_waitcnt lgkmcnt(0)
  s_barrier
  v_add_u32 v16, 0xc000, v16
  v_add_u32 v17, 0xc000, v17
  v_add_u32 v18, 0xc000, v18
  v_add_u32 v19, 0xc000, v19
  v_add_u32 v20, 0xc000, v20
  v_add_u32 v21, 0xc000, v21
  v_mfma_f32_32x32x16_bf16 v[128:143], v[56:59], v[72:75], v[128:143]
  ds_read_b64_tr_b16 v[32:33], v20 offset:0
  ds_read_b64_tr_b16 v[34:35], v20 offset:512
  ds_read_b64_tr_b16 v[36:37], v21 offset:0
  v_mfma_f32_32x32x16_bf16 v[160:175], v[60:63], v[72:75], v[160:175]
  ds_read_b64_tr_b16 v[38:39], v21 offset:512
  ds_read_b128 v[48:51], v16 offset:0
  ds_read_b64_tr_b16 v[40:41], v20 offset:8192
  v_mfma_f32_32x32x16_bf16 v[192:207], v[64:67], v[72:75], v[192:207]
  ds_read_b64_tr_b16 v[42:43], v20 offset:8704
  ds_read_b64_tr_b16 v[44:45], v21 offset:8192
  v_mfma_f32_32x32x16_bf16 v[224:239], v[68:71], v[72:75], v[224:239]
  ds_read_b64_tr_b16 v[46:47], v21 offset:8704
  ds_read_b128 v[52:55], v16 offset:4096
  v_mfma_f32_32x32x16_bf16 v[144:159], v[56:59], v[76:79], v[144:159]
  v_mfma_f32_32x32x16_bf16 v[176:191], v[60:63], v[76:79], v[176:191]
  v_mfma_f32_32x32x16_bf16 v[208:223], v[64:67], v[76:79], v[208:223]
  v_mfma_f32_32x32x16_bf16 v[240:255], v[68:71], v[76:79], v[240:255]
  s_waitcnt lgkmcnt(0)
  v_mfma_f32_32x32x16_bf16 v[128:143], v[32:35], v[48:51], v[128:143]
  ds_read_b64_tr_b16 v[56:57], v20 offset:2048
  ds_read_b64_tr_b16 v[58:59], v20 offset:2560
  ds_read_b64_tr_b16 v[60:61], v21 offset:2048
  v_mfma_f32_32x32x16_bf16 v[160:175], v[36:39], v[48:51], v[160:175]
  ds_read_b64_tr_b16 v[62:63], v21 offset:2560
  ds_read_b128 v[72:75], v17 offset:0
  ds_read_b64_tr_b16 v[64:65], v20 offset:10240
  v_mfma_f32_32x32x16_bf16 v[192:207], v[40:43], v[48:51], v[192:207]
  ds_read_b64_tr_b16 v[66:67], v20 offset:10752
  ds_read_b64_tr_b16 v[68:69], v21 offset:10240
  v_mfma_f32_32x32x16_bf16 v[224:239], v[44:47], v[48:51], v[224:239]
  ds_read_b64_tr_b16 v[70:71], v21 offset:10752
  ds_read_b128 v[76:79], v17 offset:4096
  v_mfma_f32_32x32x16_bf16 v[144:159], v[32:35], v[52:55], v[144:159]
  v_mfma_f32_32x32x16_bf16 v[176:191], v[36:39], v[52:55], v[176:191]
  v_mfma_f32_32x32x16_bf16 v[208:223], v[40:43], v[52:55], v[208:223]
  v_mfma_f32_32x32x16_bf16 v[240:255], v[44:47], v[52:55], v[240:255]
  s_waitcnt lgkmcnt(0)
  v_mfma_f32_32x32x16_bf16 v[128:143], v[56:59], v[72:75], v[128:143]
  ds_read_b64_tr_b16 v[32:33], v20 offset:4096
  ds_read_b64_tr_b16 v[34:35], v20 offset:4608
  ds_read_b64_tr_b16 v[36:37], v21 offset:4096
  v_mfma_f32_32x32x16_bf16 v[160:175], v[60:63], v[72:75], v[160:175]
  ds_read_b64_tr_b16 v[38:39], v21 offset:4608
  ds_read_b128 v[48:51], v18 offset:0
  ds_read_b64_tr_b16 v[40:41], v20 offset:12288
  v_mfma_f32_32x32x16_bf16 v[192:207], v[64:67], v[72:75], v[192:207]
  ds_read_b64_tr_b16 v[42:43], v20 offset:12800
  ds_read_b64_tr_b16 v[44:45], v21 offset:12288
  v_mfma_f32_32x32x16_bf16 v[224:239], v[68:71], v[72:75], v[224:239]
  ds_read_b64_tr_b16 v[46:47], v21 offset:12800
  ds_read_b128 v[52:55], v18 offset:4096
  v_mfma_f32_32x32x16_bf16 v[144:159], v[56:59], v[76:79], v[144:159]
  v_mfma_f32_32x32x16_bf16 v[176:191], v[60:63], v[76:79], v[176:191]
  v_mfma_f32_32x32x16_bf16 v[208:223], v[64:67], v[76:79], v[208:223]
  v_mfma_f32_32x32x16_bf16 v[240:255], v[68:71], v[76:79], v[240:255]
  s_waitcnt lgkmcnt(0)
  v_mfma_f32_32x32x16_bf16 v[128:143], v[32:35], v[48:51], v[128:143]
  ds_read_b64_tr_b16 v[56:57], v20 offset:6144
  ds_read_b64_tr_b16 v[58:59], v20 offset:6656
  ds_read_b64_tr_b16 v[60:61], v21 offset:6144
  v_mfma_f32_32x32x16_bf16 v[160:175], v[36:39], v[48:51], v[160:175]
  ds_read_b64_tr_b16 v[62:63], v21 offset:6656
  ds_read_b128 v[72:75], v19 offset:0
  ds_read_b64_tr_b16 v[64:65], v20 offset:14336
  v_mfma_f32_32x32x16_bf16 v[192:207], v[40:43], v[48:51], v[192:207]
  ds_read_b64_tr_b16 v[66:67], v20 offset:14848
  ds_read_b64_tr_b16 v[68:69], v21 offset:14336
  v_mfma_f32_32x32x16_bf16 v[224:239], v[44:47], v[48:51], v[224:239]
  ds_read_b64_tr_b16 v[70:71], v21 offset:14848
  ds_read_b128 v[76:79], v19 offset:4096
  v_mfma_f32_32x32x16_bf16 v[144:159], v[32:35], v[52:55], v[144:159]
  v_mfma_f32_32x32x16_bf16 v[176:191], v[36:39], v[52:55], v[176:191]
  v_mfma_f32_32x32x16_bf16 v[208:223], v[40:43], v[52:55], v[208:223]
  v_mfma_f32_32x32x16_bf16 v[240:255], v[44:47], v[52:55], v[240:255]
  s_waitcnt lgkmcnt(0)
  s_barrier
  v_add_u32 v16, 0xfffe8000, v16
  v_add_u32 v17, 0xfffe8000, v17
  v_add_u32 v18, 0xfffe8000, v18
  v_add_u32 v19, 0xfffe8000, v19
  v_add_u32 v20, 0xfffe8000, v20
  v_add_u32 v21, 0xfffe8000, v21
  v_mfma_f32_32x32x16_bf16 v[128:143], v[56:59], v[72:75], v[128:143]
  ds_read_b64_tr_b16 v[32:33], v20 offset:0
  ds_read_b64_tr_b16 v[34:35], v20 offset:512
  ds_read_b64_tr_b16 v[36:37], v21 offset:0
  v_mfma_f32_32x32x16_bf16 v[160:175], v[60:63], v[72:75], v[160:175]
  ds_read_b64_tr_b16 v[38:39], v21 offset:512
  ds_read_b128 v[48:51], v16 offset:0
  ds_read_b64_tr_b16 v[40:41], v20 offset:8192
  v_mfma_f32_32x32x16_bf16 v[192:207], v[64:67], v[72:75], v[192:207]
  ds_read_b64_tr_b16 v[42:43], v20 offset:8704
  ds_read_b64_tr_b16 v[44:45], v21 offset:8192
  v_mfma_f32_32x32x16_bf16 v[224:239], v[68:71], v[72:75], v[224:239]
  ds_read_b64_tr_b16 v[46:47], v21 offset:8704
  ds_read_b128 v[52:55], v16 offset:4096
  v_mfma_f32_32x32x16_bf16 v[144:159], v[56:59], v[76:79], v[144:159]
  v_mfma_f32_32x32x16_bf16 v[176:191], v[60:63], v[76:79], v[176:191]
  v_mfma_f32_32x32x16_bf16 v[208:223], v[64:67], v[76:79], v[208:223]
  v_mfma_f32_32x32x16_bf16 v[240:255], v[68:71], v[76:79], v[240:255]
  s_waitcnt lgkmcnt(0)
  v_mfma_f32_32x32x16_bf16 v[128:143], v[32:35], v[48:51], v[128:143]
  ds_read_b64_tr_b16 v[56:57], v20 offset:2048
  ds_read_b64_tr_b16 v[58:59], v20 offset:2560
  ds_read_b64_tr_b16 v[60:61], v21 offset:2048
  v_mfma_f32_32x32x16_bf16 v[160:175], v[36:39], v[48:51], v[160:175]
  ds_read_b64_tr_b16 v[62:63], v21 offset:2560
  ds_read_b128 v[72:75], v17 offset:0
  ds_read_b64_tr_b16 v[64:65], v20 offset:10240
  v_mfma_f32_32x32x16_bf16 v[192:207], v[40:43], v[48:51], v[192:207]
  ds_read_b64_tr_b16 v[66:67], v20 offset:10752
  ds_read_b64_tr_b16 v[68:69], v21 offset:10240
  v_mfma_f32_32x32x16_bf16 v[224:239], v[44:47], v[48:51], v[224:239]
  ds_read_b64_tr_b16 v[70:71], v21 offset:10752
  ds_read_b128 v[76:79], v17 offset:4096
  v_mfma_f32_32x32x16_bf16 v[144:159], v[32:35], v[52:55], v[144:159]
  v_mfma_f32_32x32x16_bf16 v[176:191], v[36:39], v[52:55], v[176:191]
  v_mfma_f32_32x32x16_bf16 v[208:223], v[40:43], v[52:55], v[208:223]
  v_mfma_f32_32x32x16_bf16 v[240:255], v[44:47], v[52:55], v[240:255]
  s_waitcnt lgkmcnt(0)
  v_mfma_f32_32x32x16_bf16 v[128:143], v[56:59], v[72:75], v[128:143]
  ds_read_b64_tr_b16 v[32:33], v20 offset:4096
  ds_read_b64_tr_b16 v[34:35], v20 offset:4608
  ds_read_b64_tr_b16 v[36:37], v21 offset:4096
  v_mfma_f32_32x32x16_bf16 v[160:175], v[60:63], v[72:75], v[160:175]
  ds_read_b64_tr_b16 v[38:39], v21 offset:4608
  ds_read_b128 v[48:51], v18 offset:0
  ds_read_b64_tr_b16 v[40:41], v20 offset:12288
  v_mfma_f32_32x32x16_bf16 v[192:207], v[64:67], v[72:75], v[192:207]
  ds_read_b64_tr_b16 v[42:43], v20 offset:12800
  ds_read_b64_tr_b16 v[44:45], v21 offset:12288
  v_mfma_f32_32x32x16_bf16 v[224:239], v[68:71], v[72:75], v[224:239]
  ds_read_b64_tr_b16 v[46:47], v21 offset:12800
  ds_read_b128 v[52:55], v18 offset:4096
  v_mfma_f32_32x32x16_bf16 v[144:159], v[56:59], v[76:79], v[144:159]
  v_mfma_f32_32x32x16_bf16 v[176:191], v[60:63], v[76:79], v[176:191]
  v_mfma_f32_32x32x16_bf16 v[208:223], v[64:67], v[76:79], v[208:223]
  v_mfma_f32_32x32x16_bf16 v[240:255], v[68:71], v[76:79], v[240:255]
  s_waitcnt lgkmcnt(0)
  v_mfma_f32_32x32x16_bf16 v[128:143], v[32:35], v[48:51], v[128:143]
  ds_read_b64_tr_b16 v[56:57], v20 offset:6144
  ds_read_b64_tr_b16 v[58:59], v20 offset:6656
  ds_read_b64_tr_b16 v[60:61], v21 offset:6144
  v_mfma_f32_32x32x16_bf16 v[160:175], v[36:39], v[48:51], v[160:175]
  ds_read_b64_tr_b16 v[62:63], v21 offset:6656
  ds_read_b128 v[72:75], v19 offset:0
  ds_read_b64_tr_b16 v[64:65], v20 offset:14336
  v_mfma_f32_32x32x16_bf16 v[192:207], v[40:43], v[48:51], v[192:207]
  ds_read_b64_tr_b16 v[66:67], v20 offset:14848
  ds_read_b64_tr_b16 v[68:69], v21 offset:14336
  v_mfma_f32_32x32x16_bf16 v[224:239], v[44:47], v[48:51], v[224:239]
  ds_read_b64_tr_b16 v[70:71], v21 offset:14848
  ds_read_b128 v[76:79], v19 offset:4096
  v_mfma_f32_32x32x16_bf16 v[144:159], v[32:35], v[52:55], v[144:159]
  v_mfma_f32_32x32x16_bf16 v[176:191], v[36:39], v[52:55], v[176:191]
  v_mfma_f32_32x32x16_bf16 v[208:223], v[40:43], v[52:55], v[208:223]
  v_mfma_f32_32x32x16_bf16 v[240:255], v[44:47], v[52:55], v[240:255]
  s_waitcnt lgkmcnt(0)
  s_barrier
  v_add_u32 v16, 0xc000, v16
  v_add_u32 v17, 0xc000, v17
  v_add_u32 v18, 0xc000, v18
  v_add_u32 v19, 0xc000, v19
  v_add_u32 v20, 0xc000, v20
  v_add_u32 v21, 0xc000, v21
  v_mfma_f32_32x32x16_bf16 v[128:143], v[56:59], v[72:75], v[128:143]
  ds_read_b64_tr_b16 v[32:33], v20 offset:0
  ds_read_b64_tr_b16 v[34:35], v20 offset:512
  ds_read_b64_tr_b16 v[36:37], v21 offset:0
  v_mfma_f32_32x32x16_bf16 v[160:175], v[60:63], v[72:75], v[160:175]
  ds_read_b64_tr_b16 v[38:39], v21 offset:512
  ds_read_b128 v[48:51], v16 offset:0
  ds_read_b64_tr_b16 v[40:41], v20 offset:8192
  v_mfma_f32_32x32x16_bf16 v[192:207], v[64:67], v[72:75], v[192:207]
  ds_read_b64_tr_b16 v[42:43], v20 offset:8704
  ds_read_b64_tr_b16 v[44:45], v21 offset:8192
  v_mfma_f32_32x32x16_bf16 v[224:239], v[68:71], v[72:75], v[224:239]
  ds_read_b64_tr_b16 v[46:47], v21 offset:8704
  ds_read_b128 v[52:55], v16 offset:4096
  v_mfma_f32_32x32x16_bf16 v[144:159], v[56:59], v[76:79], v[144:159]
  v_mfma_f32_32x32x16_bf16 v[176:191], v[60:63], v[76:79], v[176:191]
  v_mfma_f32_32x32x16_bf16 v[208:223], v[64:67], v[76:79], v[208:223]
  v_mfma_f32_32x32x16_bf16 v[240:255], v[68:71], v[76:79], v[240:255]
  s_waitcnt lgkmcnt(0)
  v_mfma_f32_32x32x16_bf16 v[128:143], v[32:35], v[48:51], v[128:143]
  ds_read_b64_tr_b16 v[56:57], v20 offset:2048
  ds_read_b64_tr_b16 v[58:59], v20 offset:2560
  ds_read_b64_tr_b16 v[60:61], v21 offset:2048
  v_mfma_f32_32x32x16_bf16 v[160:175], v[36:39], v[48:51], v[160:175]
  ds_read_b64_tr_b16 v[62:63], v21 offset:2560
  ds_read_b128 v[72:75], v17 offset:0
  ds_read_b64_tr_b16 v[64:65], v20 offset:10240
  v_mfma_f32_32x32x16_bf16 v[192:207], v[40:43], v[48:51], v[192:207]
  ds_read_b64_tr_b16 v[66:67], v20 offset:10752
  ds_read_b64_tr_b16 v[68:69], v21 offset:10240
  v_mfma_f32_32x32x16_bf16 v[224:239], v[44:47], v[48:51], v[224:239]
  ds_read_b64_tr_b16 v[70:71], v21 offset:10752
  ds_read_b128 v[76:79], v17 offset:4096
  v_mfma_f32_32x32x16_bf16 v[144:159], v[32:35], v[52:55], v[144:159]
  v_mfma_f32_32x32x16_bf16 v[176:191], v[36:39], v[52:55], v[176:191]
  v_mfma_f32_32x32x16_bf16 v[208:223], v[40:43], v[52:55], v[208:223]
  v_mfma_f32_32x32x16_bf16 v[240:255], v[44:47], v[52:55], v[240:255]
  s_waitcnt lgkmcnt(0)
  v_mfma_f32_32x32x16_bf16 v[128:143], v[56:59], v[72:75], v[128:143]
  ds_read_b64_tr_b16 v[32:33], v20 offset:4096
  ds_read_b64_tr_b16 v[34:35], v20 offset:4608
  ds_read_b64_tr_b16 v[36:37], v21 offset:4096
  v_mfma_f32_32x32x16_bf16 v[160:175], v[60:63], v[72:75], v[160:175]
  ds_read_b64_tr_b16 v[38:39], v21 offset:4608
  ds_read_b128 v[48:51], v18 offset:0
  ds_read_b64_tr_b16 v[40:41], v20 offset:12288
  v_mfma_f32_32x32x16_bf16 v[192:207], v[64:67], v[72:75], v[192:207]
  ds_read_b64_tr_b16 v[42:43], v20 offset:12800
  ds_read_b64_tr_b16 v[44:45], v21 offset:12288
  v_mfma_f32_32x32x16_bf16 v[224:239], v[68:71], v[72:75], v[224:239]
  ds_read_b64_tr_b16 v[46:47], v21 offset:12800
  ds_read_b128 v[52:55], v18 offset:4096
  v_mfma_f32_32x32x16_bf16 v[144:159], v[56:59], v[76:79], v[144:159]
  v_mfma_f32_32x32x16_bf16 v[176:191], v[60:63], v[76:79], v[176:191]
  v_mfma_f32_32x32x16_bf16 v[208:223], v[64:67], v[76:79], v[208:223]
  v_mfma_f32_32x32x16_bf16 v[240:255], v[68:71], v[76:79], v[240:255]
  s_waitcnt lgkmcnt(0)
  v_mfma_f32_32x32x16_bf16 v[128:143], v[32:35], v[48:51], v[128:143]
  ds_read_b64_tr_b16 v[56:57], v20 offset:6144
  ds_read_b64_tr_b16 v[58:59], v20 offset:6656
  ds_read_b64_tr_b16 v[60:61], v21 offset:6144
  v_mfma_f32_32x32x16_bf16 v[160:175], v[36:39], v[48:51], v[160:175]
  ds_read_b64_tr_b16 v[62:63], v21 offset:6656
  ds_read_b128 v[72:75], v19 offset:0
  ds_read_b64_tr_b16 v[64:65], v20 offset:14336
  v_mfma_f32_32x32x16_bf16 v[192:207], v[40:43], v[48:51], v[192:207]
  ds_read_b64_tr_b16 v[66:67], v20 offset:14848
  ds_read_b64_tr_b16 v[68:69], v21 offset:14336
  v_mfma_f32_32x32x16_bf16 v[224:239], v[44:47], v[48:51], v[224:239]
  ds_read_b64_tr_b16 v[70:71], v21 offset:14848
  ds_read_b128 v[76:79], v19 offset:4096
  v_mfma_f32_32x32x16_bf16 v[144:159], v[32:35], v[52:55], v[144:159]
  v_mfma_f32_32x32x16_bf16 v[176:191], v[36:39], v[52:55], v[176:191]
  v_mfma_f32_32x32x16_bf16 v[208:223], v[40:43], v[52:55], v[208:223]
  v_mfma_f32_32x32x16_bf16 v[240:255], v[44:47], v[52:55], v[240:255]
  s_waitcnt lgkmcnt(0)
  s_barrier
  v_add_u32 v16, 0xc000, v16
  v_add_u32 v17, 0xc000, v17
  v_add_u32 v18, 0xc000, v18
  v_add_u32 v19, 0xc000, v19
  v_add_u32 v20, 0xc000, v20
  v_add_u32 v21, 0xc000, v21
  v_mfma_f32_32x32x16_bf16 v[128:143], v[56:59], v[72:75], v[128:143]
  ds_read_b64_tr_b16 v[32:33], v20 offset:0
  ds_read_b64_tr_b16 v[34:35], v20 offset:512
  ds_read_b64_tr_b16 v[36:37], v21 offset:0
  v_mfma_f32_32x32x16_bf16 v[160:175], v[60:63], v[72:75], v[160:175]
  ds_read_b64_tr_b16 v[38:39], v21 offset:512
  ds_read_b128 v[48:51], v16 offset:0
  ds_read_b64_tr_b16 v[40:41], v20 offset:8192
  v_mfma_f32_32x32x16_bf16 v[192:207], v[64:67], v[72:75], v[192:207]
  ds_read_b64_tr_b16 v[42:43], v20 offset:8704
  ds_read_b64_tr_b16 v[44:45], v21 offset:8192
  v_mfma_f32_32x32x16_bf16 v[224:239], v[68:71], v[72:75], v[224:239]
  ds_read_b64_tr_b16 v[46:47], v21 offset:8704
  ds_read_b128 v[52:55], v16 offset:4096
  v_mfma_f32_32x32x16_bf16 v[144:159], v[56:59], v[76:79], v[144:159]
  v_mfma_f32_32x32x16_bf16 v[176:191], v[60:63], v[76:79], v[176:191]
  v_mfma_f32_32x32x16_bf16 v[208:223], v[64:67], v[76:79], v[208:223]
  v_mfma_f32_32x32x16_bf16 v[240:255], v[68:71], v[76:79], v[240:255]
  s_waitcnt lgkmcnt(0)
  v_mfma_f32_32x32x16_bf16 v[128:143], v[32:35], v[48:51], v[128:143]
  ds_read_b64_tr_b16 v[56:57], v20 offset:2048
  ds_read_b64_tr_b16 v[58:59], v20 offset:2560
  ds_read_b64_tr_b16 v[60:61], v21 offset:2048
  v_mfma_f32_32x32x16_bf16 v[160:175], v[36:39], v[48:51], v[160:175]
  ds_read_b64_tr_b16 v[62:63], v21 offset:2560
  ds_read_b128 v[72:75], v17 offset:0
  ds_read_b64_tr_b16 v[64:65], v20 offset:10240
  v_mfma_f32_32x32x16_bf16 v[192:207], v[40:43], v[48:51], v[192:207]
  ds_read_b64_tr_b16 v[66:67], v20 offset:10752
  ds_read_b64_tr_b16 v[68:69], v21 offset:10240
  v_mfma_f32_32x32x16_bf16 v[224:239], v[44:47], v[48:51], v[224:239]
  ds_read_b64_tr_b16 v[70:71], v21 offset:10752
  ds_read_b128 v[76:79], v17 offset:4096
  v_mfma_f32_32x32x16_bf16 v[144:159], v[32:35], v[52:55], v[144:159]
  v_mfma_f32_32x32x16_bf16 v[176:191], v[36:39], v[52:55], v[176:191]
  v_mfma_f32_32x32x16_bf16 v[208:223], v[40:43], v[52:55], v[208:223]
  v_mfma_f32_32x32x16_bf16 v[240:255], v[44:47], v[52:55], v[240:255]
  s_waitcnt lgkmcnt(0)
  v_mfma_f32_32x32x16_bf16 v[128:143], v[56:59], v[72:75], v[128:143]
  ds_read_b64_tr_b16 v[32:33], v20 offset:4096
  ds_read_b64_tr_b16 v[34:35], v20 offset:4608
  ds_read_b64_tr_b16 v[36:37], v21 offset:4096
  v_mfma_f32_32x32x16_bf16 v[160:175], v[60:63], v[72:75], v[160:175]
  ds_read_b64_tr_b16 v[38:39], v21 offset:4608
  ds_read_b128 v[48:51], v18 offset:0
  ds_read_b64_tr_b16 v[40:41], v20 offset:12288
  v_mfma_f32_32x32x16_bf16 v[192:207], v[64:67], v[72:75], v[192:207]
  ds_read_b64_tr_b16 v[42:43], v20 offset:12800
  ds_read_b64_tr_b16 v[44:45], v21 offset:12288
  v_mfma_f32_32x32x16_bf16 v[224:239], v[68:71], v[72:75], v[224:239]
  ds_read_b64_tr_b16 v[46:47], v21 offset:12800
  ds_read_b128 v[52:55], v18 offset:4096
  v_mfma_f32_32x32x16_bf16 v[144:159], v[56:59], v[76:79], v[144:159]
  v_mfma_f32_32x32x16_bf16 v[176:191], v[60:63], v[76:79], v[176:191]
  v_mfma_f32_32x32x16_bf16 v[208:223], v[64:67], v[76:79], v[208:223]
  v_mfma_f32_32x32x16_bf16 v[240:255], v[68:71], v[76:79], v[240:255]
  s_waitcnt lgkmcnt(0)
  v_mfma_f32_32x32x16_bf16 v[128:143], v[32:35], v[48:51], v[128:143]
  ds_read_b64_tr_b16 v[56:57], v20 offset:6144
  ds_read_b64_tr_b16 v[58:59], v20 offset:6656
  ds_read_b64_tr_b16 v[60:61], v21 offset:6144
  v_mfma_f32_32x32x16_bf16 v[160:175], v[36:39], v[48:51], v[160:175]
  ds_read_b64_tr_b16 v[62:63], v21 offset:6656
  ds_read_b128 v[72:75], v19 offset:0
  ds_read_b64_tr_b16 v[64:65], v20 offset:14336
  v_mfma_f32_32x32x16_bf16 v[192:207], v[40:43], v[48:51], v[192:207]
  ds_read_b64_tr_b16 v[66:67], v20 offset:14848
  ds_read_b64_tr_b16 v[68:69], v21 offset:14336
  v_mfma_f32_32x32x16_bf16 v[224:239], v[44:47], v[48:51], v[224:239]
  ds_read_b64_tr_b16 v[70:71], v21 offset:14848
  ds_read_b128 v[76:79], v19 offset:4096
  v_mfma_f32_32x32x16_bf16 v[144:159], v[32:35], v[52:55], v[144:159]
  v_mfma_f32_32x32x16_bf16 v[176:191], v[36:39], v[52:55], v[176:191]
  v_mfma_f32_32x32x16_bf16 v[208:223], v[40:43], v[52:55], v[208:223]
  v_mfma_f32_32x32x16_bf16 v[240:255], v[44:47], v[52:55], v[240:255]
  s_waitcnt lgkmcnt(0)
  s_barrier
  v_add_u32 v16, 0xfffe8000, v16
  v_add_u32 v17, 0xfffe8000, v17
  v_add_u32 v18, 0xfffe8000, v18
  v_add_u32 v19, 0xfffe8000, v19
  v_add_u32 v20, 0xfffe8000, v20
  v_add_u32 v21, 0xfffe8000, v21
  v_mfma_f32_32x32x16_bf16 v[128:143], v[56:59], v[72:75], v[128:143]
  ds_read_b64_tr_b16 v[32:33], v20 offset:0
  ds_read_b64_tr_b16 v[34:35], v20 offset:512
  ds_read_b64_tr_b16 v[36:37], v21 offset:0
  v_mfma_f32_32x32x16_bf16 v[160:175], v[60:63], v[72:75], v[160:175]
  ds_read_b64_tr_b16 v[38:39], v21 offset:512
  ds_read_b128 v[48:51], v16 offset:0
  ds_read_b64_tr_b16 v[40:41], v20 offset:8192
  v_mfma_f32_32x32x16_bf16 v[192:207], v[64:67], v[72:75], v[192:207]
  ds_read_b64_tr_b16 v[42:43], v20 offset:8704
  ds_read_b64_tr_b16 v[44:45], v21 offset:8192
  v_mfma_f32_32x32x16_bf16 v[224:239], v[68:71], v[72:75], v[224:239]
  ds_read_b64_tr_b16 v[46:47], v21 offset:8704
  ds_read_b128 v[52:55], v16 offset:4096
  v_mfma_f32_32x32x16_bf16 v[144:159], v[56:59], v[76:79], v[144:159]
  v_mfma_f32_32x32x16_bf16 v[176:191], v[60:63], v[76:79], v[176:191]
  v_mfma_f32_32x32x16_bf16 v[208:223], v[64:67], v[76:79], v[208:223]
  v_mfma_f32_32x32x16_bf16 v[240:255], v[68:71], v[76:79], v[240:255]
  s_waitcnt lgkmcnt(0)
  v_mfma_f32_32x32x16_bf16 v[128:143], v[32:35], v[48:51], v[128:143]
  ds_read_b64_tr_b16 v[56:57], v20 offset:2048
  ds_read_b64_tr_b16 v[58:59], v20 offset:2560
  ds_read_b64_tr_b16 v[60:61], v21 offset:2048
  v_mfma_f32_32x32x16_bf16 v[160:175], v[36:39], v[48:51], v[160:175]
  ds_read_b64_tr_b16 v[62:63], v21 offset:2560
  ds_read_b128 v[72:75], v17 offset:0
  ds_read_b64_tr_b16 v[64:65], v20 offset:10240
  v_mfma_f32_32x32x16_bf16 v[192:207], v[40:43], v[48:51], v[192:207]
  ds_read_b64_tr_b16 v[66:67], v20 offset:10752
  ds_read_b64_tr_b16 v[68:69], v21 offset:10240
  v_mfma_f32_32x32x16_bf16 v[224:239], v[44:47], v[48:51], v[224:239]
  ds_read_b64_tr_b16 v[70:71], v21 offset:10752
  ds_read_b128 v[76:79], v17 offset:4096
  v_mfma_f32_32x32x16_bf16 v[144:159], v[32:35], v[52:55], v[144:159]
  v_mfma_f32_32x32x16_bf16 v[176:191], v[36:39], v[52:55], v[176:191]
  v_mfma_f32_32x32x16_bf16 v[208:223], v[40:43], v[52:55], v[208:223]
  v_mfma_f32_32x32x16_bf16 v[240:255], v[44:47], v[52:55], v[240:255]
  s_waitcnt lgkmcnt(0)
  v_mfma_f32_32x32x16_bf16 v[128:143], v[56:59], v[72:75], v[128:143]
  ds_read_b64_tr_b16 v[32:33], v20 offset:4096
  ds_read_b64_tr_b16 v[34:35], v20 offset:4608
  ds_read_b64_tr_b16 v[36:37], v21 offset:4096
  v_mfma_f32_32x32x16_bf16 v[160:175], v[60:63], v[72:75], v[160:175]
  ds_read_b64_tr_b16 v[38:39], v21 offset:4608
  ds_read_b128 v[48:51], v18 offset:0
  ds_read_b64_tr_b16 v[40:41], v20 offset:12288
  v_mfma_f32_32x32x16_bf16 v[192:207], v[64:67], v[72:75], v[192:207]
  ds_read_b64_tr_b16 v[42:43], v20 offset:12800
  ds_read_b64_tr_b16 v[44:45], v21 offset:12288
  v_mfma_f32_32x32x16_bf16 v[224:239], v[68:71], v[72:75], v[224:239]
  ds_read_b64_tr_b16 v[46:47], v21 offset:12800
  ds_read_b128 v[52:55], v18 offset:4096
  v_mfma_f32_32x32x16_bf16 v[144:159], v[56:59], v[76:79], v[144:159]
  v_mfma_f32_32x32x16_bf16 v[176:191], v[60:63], v[76:79], v[176:191]
  v_mfma_f32_32x32x16_bf16 v[208:223], v[64:67], v[76:79], v[208:223]
  v_mfma_f32_32x32x16_bf16 v[240:255], v[68:71], v[76:79], v[240:255]
  s_waitcnt lgkmcnt(0)
  v_mfma_f32_32x32x16_bf16 v[128:143], v[32:35], v[48:51], v[128:143]
  ds_read_b64_tr_b16 v[56:57], v20 offset:6144
  ds_read_b64_tr_b16 v[58:59], v20 offset:6656
  ds_read_b64_tr_b16 v[60:61], v21 offset:6144
  v_mfma_f32_32x32x16_bf16 v[160:175], v[36:39], v[48:51], v[160:175]
  ds_read_b64_tr_b16 v[62:63], v21 offset:6656
  ds_read_b128 v[72:75], v19 offset:0
  ds_read_b64_tr_b16 v[64:65], v20 offset:14336
  v_mfma_f32_32x32x16_bf16 v[192:207], v[40:43], v[48:51], v[192:207]
  ds_read_b64_tr_b16 v[66:67], v20 offset:14848
  ds_read_b64_tr_b16 v[68:69], v21 offset:14336
  v_mfma_f32_32x32x16_bf16 v[224:239], v[44:47], v[48:51], v[224:239]
  ds_read_b64_tr_b16 v[70:71], v21 offset:14848
  ds_read_b128 v[76:79], v19 offset:4096
  v_mfma_f32_32x32x16_bf16 v[144:159], v[32:35], v[52:55], v[144:159]
  v_mfma_f32_32x32x16_bf16 v[176:191], v[36:39], v[52:55], v[176:191]
  v_mfma_f32_32x32x16_bf16 v[208:223], v[40:43], v[52:55], v[208:223]
  v_mfma_f32_32x32x16_bf16 v[240:255], v[44:47], v[52:55], v[240:255]
  s_waitcnt lgkmcnt(0)
  s_barrier
  v_add_u32 v16, 0xc000, v16
  v_add_u32 v17, 0xc000, v17
  v_add_u32 v18, 0xc000, v18
  v_add_u32 v19, 0xc000, v19
  v_add_u32 v20, 0xc000, v20
  v_add_u32 v21, 0xc000, v21
  v_mfma_f32_32x32x16_bf16 v[128:143], v[56:59], v[72:75], v[128:143]
  ds_read_b64_tr_b16 v[32:33], v20 offset:0
  ds_read_b64_tr_b16 v[34:35], v20 offset:512
  ds_read_b64_tr_b16 v[36:37], v21 offset:0
  ds_read_b64_tr_b16 v[38:39], v21 offset:512
  v_mfma_f32_32x32x16_bf16 v[160:175], v[60:63], v[72:75], v[160:175]
  ds_read_b128 v[48:51], v16 offset:0
  ds_read_b64_tr_b16 v[40:41], v20 offset:8192
  ds_read_b64_tr_b16 v[42:43], v20 offset:8704
  ds_read_b64_tr_b16 v[44:45], v21 offset:8192
  v_mfma_f32_32x32x16_bf16 v[192:207], v[64:67], v[72:75], v[192:207]
  ds_read_b64_tr_b16 v[46:47], v21 offset:8704
  ds_read_b128 v[52:55], v16 offset:4096
  ds_read_b64_tr_b16 v[80:81], v20 offset:4096
  ds_read_b64_tr_b16 v[82:83], v20 offset:4608
  v_mfma_f32_32x32x16_bf16 v[224:239], v[68:71], v[72:75], v[224:239]
  ds_read_b64_tr_b16 v[84:85], v21 offset:4096
  ds_read_b64_tr_b16 v[86:87], v21 offset:4608
  ds_read_b128 v[96:99], v18 offset:0
  ds_read_b64_tr_b16 v[88:89], v20 offset:12288
  v_mfma_f32_32x32x16_bf16 v[144:159], v[56:59], v[76:79], v[144:159]
  ds_read_b64_tr_b16 v[90:91], v20 offset:12800
  ds_read_b64_tr_b16 v[92:93], v21 offset:12288
  ds_read_b64_tr_b16 v[94:95], v21 offset:12800
  ds_read_b128 v[100:103], v18 offset:4096
  v_mfma_f32_32x32x16_bf16 v[176:191], v[60:63], v[76:79], v[176:191]
  ds_read_b64_tr_b16 v[104:105], v20 offset:6144
  ds_read_b64_tr_b16 v[106:107], v20 offset:6656
  ds_read_b64_tr_b16 v[108:109], v21 offset:6144
  ds_read_b64_tr_b16 v[110:111], v21 offset:6656
  v_mfma_f32_32x32x16_bf16 v[208:223], v[64:67], v[76:79], v[208:223]
  ds_read_b128 v[120:123], v19 offset:0
  ds_read_b64_tr_b16 v[112:113], v20 offset:14336
  ds_read_b64_tr_b16 v[114:115], v20 offset:14848
  ds_read_b64_tr_b16 v[116:117], v21 offset:14336
  v_mfma_f32_32x32x16_bf16 v[240:255], v[68:71], v[76:79], v[240:255]
  ds_read_b64_tr_b16 v[118:119], v21 offset:14848
  ds_read_b128 v[124:127], v19 offset:4096
  ds_read_b64_tr_b16 v[56:57], v20 offset:2048
  ds_read_b64_tr_b16 v[58:59], v20 offset:2560
  ds_read_b64_tr_b16 v[60:61], v21 offset:2048
  ds_read_b64_tr_b16 v[62:63], v21 offset:2560
  ds_read_b128 v[72:75], v17 offset:0
  ds_read_b64_tr_b16 v[64:65], v20 offset:10240
  ds_read_b64_tr_b16 v[66:67], v20 offset:10752
  ds_read_b64_tr_b16 v[68:69], v21 offset:10240
  ds_read_b64_tr_b16 v[70:71], v21 offset:10752
  ds_read_b128 v[76:79], v17 offset:4096
  s_waitcnt lgkmcnt(10)
  v_mfma_f32_32x32x16_bf16 v[128:143], v[32:35], v[48:51], v[128:143]
  v_mfma_f32_32x32x16_bf16 v[192:207], v[40:43], v[48:51], v[192:207]
  v_mfma_f32_32x32x16_bf16 v[128:143], v[80:83], v[96:99], v[128:143]
  v_mfma_f32_32x32x16_bf16 v[192:207], v[88:91], v[96:99], v[192:207]
  v_mfma_f32_32x32x16_bf16 v[128:143], v[104:107], v[120:123], v[128:143]
  v_mfma_f32_32x32x16_bf16 v[192:207], v[112:115], v[120:123], v[192:207]
  s_waitcnt lgkmcnt(0)
  v_mfma_f32_32x32x16_bf16 v[128:143], v[56:59], v[72:75], v[128:143]
  v_mfma_f32_32x32x16_bf16 v[192:207], v[64:67], v[72:75], v[192:207]
  v_mfma_f32_32x32x16_bf16 v[160:175], v[36:39], v[48:51], v[160:175]
  v_mfma_f32_32x32x16_bf16 v[224:239], v[44:47], v[48:51], v[224:239]
  s_nop 8
  v_cvt_pk_bf16_f32 v128, v128, v129
  v_cvt_pk_bf16_f32 v192, v192, v193
  v_cvt_pk_bf16_f32 v130, v130, v131
  v_cvt_pk_bf16_f32 v194, v194, v195
  v_cvt_pk_bf16_f32 v132, v132, v133
  v_cvt_pk_bf16_f32 v196, v196, v197
  v_cvt_pk_bf16_f32 v134, v134, v135
  v_cvt_pk_bf16_f32 v198, v198, v199
  v_cvt_pk_bf16_f32 v136, v136, v137
  v_mfma_f32_32x32x16_bf16 v[160:175], v[84:87], v[96:99], v[160:175]
  v_cvt_pk_bf16_f32 v200, v200, v201
  v_cvt_pk_bf16_f32 v138, v138, v139
  v_cvt_pk_bf16_f32 v202, v202, v203
  v_cvt_pk_bf16_f32 v140, v140, v141
  v_cvt_pk_bf16_f32 v204, v204, v205
  v_cvt_pk_bf16_f32 v142, v142, v143
  v_cvt_pk_bf16_f32 v206, v206, v207
  v_max_i16_sdwa v129, v128, v12 dst_sel:WORD_0 dst_unused:UNUSED_PAD src0_sel:WORD_0 src1_sel:WORD_0
  v_max_i16_sdwa v193, v128, v12 dst_sel:WORD_1 dst_unused:UNUSED_PAD src0_sel:WORD_1 src1_sel:WORD_0
  v_max_i16_sdwa v131, v130, v12 dst_sel:WORD_0 dst_unused:UNUSED_PAD src0_sel:WORD_0 src1_sel:WORD_0
  v_mfma_f32_32x32x16_bf16 v[224:239], v[92:95], v[96:99], v[224:239]
  v_max_i16_sdwa v195, v130, v12 dst_sel:WORD_1 dst_unused:UNUSED_PAD src0_sel:WORD_1 src1_sel:WORD_0
  v_max_i16_sdwa v133, v132, v12 dst_sel:WORD_0 dst_unused:UNUSED_PAD src0_sel:WORD_0 src1_sel:WORD_0
  v_max_i16_sdwa v197, v132, v12 dst_sel:WORD_1 dst_unused:UNUSED_PAD src0_sel:WORD_1 src1_sel:WORD_0
  v_max_i16_sdwa v135, v134, v12 dst_sel:WORD_0 dst_unused:UNUSED_PAD src0_sel:WORD_0 src1_sel:WORD_0
  v_max_i16_sdwa v199, v134, v12 dst_sel:WORD_1 dst_unused:UNUSED_PAD src0_sel:WORD_1 src1_sel:WORD_0
  v_max_i16_sdwa v137, v136, v12 dst_sel:WORD_0 dst_unused:UNUSED_PAD src0_sel:WORD_0 src1_sel:WORD_0
  v_max_i16_sdwa v201, v136, v12 dst_sel:WORD_1 dst_unused:UNUSED_PAD src0_sel:WORD_1 src1_sel:WORD_0
  v_max_i16_sdwa v139, v138, v12 dst_sel:WORD_0 dst_unused:UNUSED_PAD src0_sel:WORD_0 src1_sel:WORD_0
  v_max_i16_sdwa v203, v138, v12 dst_sel:WORD_1 dst_unused:UNUSED_PAD src0_sel:WORD_1 src1_sel:WORD_0
  v_max_i16_sdwa v141, v140, v12 dst_sel:WORD_0 dst_unused:UNUSED_PAD src0_sel:WORD_0 src1_sel:WORD_0
  v_mfma_f32_32x32x16_bf16 v[160:175], v[108:111], v[120:123], v[160:175]
  v_max_i16_sdwa v205, v140, v12 dst_sel:WORD_1 dst_unused:UNUSED_PAD src0_sel:WORD_1 src1_sel:WORD_0
  v_max_i16_sdwa v143, v142, v12 dst_sel:WORD_0 dst_unused:UNUSED_PAD src0_sel:WORD_0 src1_sel:WORD_0
  v_max_i16_sdwa v207, v142, v12 dst_sel:WORD_1 dst_unused:UNUSED_PAD src0_sel:WORD_1 src1_sel:WORD_0
  v_dot2_f32_bf16 v129, v129, v192, 0
  v_dot2_f32_bf16 v193, v193, v192, 0
  v_dot2_f32_bf16 v131, v131, v194, 0
  v_dot2_f32_bf16 v195, v195, v194, 0
  v_dot2_f32_bf16 v133, v133, v196, 0
  v_dot2_f32_bf16 v197, v197, v196, 0
  v_dot2_f32_bf16 v135, v135, v198, 0
  v_mfma_f32_32x32x16_bf16 v[224:239], v[116:119], v[120:123], v[224:239]
  v_dot2_f32_bf16 v199, v199, v198, 0
  v_dot2_f32_bf16 v137, v137, v200, 0
  v_dot2_f32_bf16 v201, v201, v200, 0
  v_dot2_f32_bf16 v139, v139, v202, 0
  v_dot2_f32_bf16 v203, v203, v202, 0
  v_dot2_f32_bf16 v141, v141, v204, 0
  v_dot2_f32_bf16 v205, v205, v204, 0
  v_dot2_f32_bf16 v143, v143, v206, 0
  v_dot2_f32_bf16 v207, v207, v206, 0
  v_cvt_pk_bf16_f32 v4, v129, v193
  v_mfma_f32_32x32x16_bf16 v[160:175], v[60:63], v[72:75], v[160:175]
  v_cvt_pk_bf16_f32 v5, v131, v195
  v_cvt_pk_bf16_f32 v6, v133, v197
  v_cvt_pk_bf16_f32 v7, v135, v199
  ds_write_b128 v22, v[4:7] offset:0
  v_cvt_pk_bf16_f32 v8, v137, v201
  v_cvt_pk_bf16_f32 v9, v139, v203
  v_cvt_pk_bf16_f32 v10, v141, v205
  v_cvt_pk_bf16_f32 v11, v143, v207
  ds_write_b128 v22, v[8:11] offset:16
  v_mfma_f32_32x32x16_bf16 v[224:239], v[68:71], v[72:75], v[224:239]
  v_mfma_f32_32x32x16_bf16 v[144:159], v[32:35], v[52:55], v[144:159]
  v_mfma_f32_32x32x16_bf16 v[208:223], v[40:43], v[52:55], v[208:223]
  s_nop 8
  v_cvt_pk_bf16_f32 v160, v160, v161
  v_cvt_pk_bf16_f32 v224, v224, v225
  v_cvt_pk_bf16_f32 v162, v162, v163
  v_cvt_pk_bf16_f32 v226, v226, v227
  v_cvt_pk_bf16_f32 v164, v164, v165
  v_cvt_pk_bf16_f32 v228, v228, v229
  v_cvt_pk_bf16_f32 v166, v166, v167
  v_cvt_pk_bf16_f32 v230, v230, v231
  v_cvt_pk_bf16_f32 v168, v168, v169
  v_mfma_f32_32x32x16_bf16 v[144:159], v[80:83], v[100:103], v[144:159]
  v_cvt_pk_bf16_f32 v232, v232, v233
  v_cvt_pk_bf16_f32 v170, v170, v171
  v_cvt_pk_bf16_f32 v234, v234, v235
  v_cvt_pk_bf16_f32 v172, v172, v173
  v_cvt_pk_bf16_f32 v236, v236, v237
  v_cvt_pk_bf16_f32 v174, v174, v175
  v_cvt_pk_bf16_f32 v238, v238, v239
  v_max_i16_sdwa v161, v160, v12 dst_sel:WORD_0 dst_unused:UNUSED_PAD src0_sel:WORD_0 src1_sel:WORD_0
  v_max_i16_sdwa v225, v160, v12 dst_sel:WORD_1 dst_unused:UNUSED_PAD src0_sel:WORD_1 src1_sel:WORD_0
  v_max_i16_sdwa v163, v162, v12 dst_sel:WORD_0 dst_unused:UNUSED_PAD src0_sel:WORD_0 src1_sel:WORD_0
  v_mfma_f32_32x32x16_bf16 v[208:223], v[88:91], v[100:103], v[208:223]
  v_max_i16_sdwa v227, v162, v12 dst_sel:WORD_1 dst_unused:UNUSED_PAD src0_sel:WORD_1 src1_sel:WORD_0
  v_max_i16_sdwa v165, v164, v12 dst_sel:WORD_0 dst_unused:UNUSED_PAD src0_sel:WORD_0 src1_sel:WORD_0
  v_max_i16_sdwa v229, v164, v12 dst_sel:WORD_1 dst_unused:UNUSED_PAD src0_sel:WORD_1 src1_sel:WORD_0
  v_max_i16_sdwa v167, v166, v12 dst_sel:WORD_0 dst_unused:UNUSED_PAD src0_sel:WORD_0 src1_sel:WORD_0
  v_max_i16_sdwa v231, v166, v12 dst_sel:WORD_1 dst_unused:UNUSED_PAD src0_sel:WORD_1 src1_sel:WORD_0
  v_max_i16_sdwa v169, v168, v12 dst_sel:WORD_0 dst_unused:UNUSED_PAD src0_sel:WORD_0 src1_sel:WORD_0
  v_max_i16_sdwa v233, v168, v12 dst_sel:WORD_1 dst_unused:UNUSED_PAD src0_sel:WORD_1 src1_sel:WORD_0
  v_max_i16_sdwa v171, v170, v12 dst_sel:WORD_0 dst_unused:UNUSED_PAD src0_sel:WORD_0 src1_sel:WORD_0
  v_max_i16_sdwa v235, v170, v12 dst_sel:WORD_1 dst_unused:UNUSED_PAD src0_sel:WORD_1 src1_sel:WORD_0
  v_max_i16_sdwa v173, v172, v12 dst_sel:WORD_0 dst_unused:UNUSED_PAD src0_sel:WORD_0 src1_sel:WORD_0
  v_mfma_f32_32x32x16_bf16 v[144:159], v[104:107], v[124:127], v[144:159]
  v_max_i16_sdwa v237, v172, v12 dst_sel:WORD_1 dst_unused:UNUSED_PAD src0_sel:WORD_1 src1_sel:WORD_0
  v_max_i16_sdwa v175, v174, v12 dst_sel:WORD_0 dst_unused:UNUSED_PAD src0_sel:WORD_0 src1_sel:WORD_0
  v_max_i16_sdwa v239, v174, v12 dst_sel:WORD_1 dst_unused:UNUSED_PAD src0_sel:WORD_1 src1_sel:WORD_0
  v_dot2_f32_bf16 v161, v161, v224, 0
  v_dot2_f32_bf16 v225, v225, v224, 0
  v_dot2_f32_bf16 v163, v163, v226, 0
  v_dot2_f32_bf16 v227, v227, v226, 0
  v_dot2_f32_bf16 v165, v165, v228, 0
  v_dot2_f32_bf16 v229, v229, v228, 0
  v_dot2_f32_bf16 v167, v167, v230, 0
  v_mfma_f32_32x32x16_bf16 v[208:223], v[112:115], v[124:127], v[208:223]
  v_dot2_f32_bf16 v231, v231, v230, 0
  v_dot2_f32_bf16 v169, v169, v232, 0
  v_dot2_f32_bf16 v233, v233, v232, 0
  v_dot2_f32_bf16 v171, v171, v234, 0
  v_dot2_f32_bf16 v235, v235, v234, 0
  v_dot2_f32_bf16 v173, v173, v236, 0
  v_dot2_f32_bf16 v237, v237, v236, 0
  v_dot2_f32_bf16 v175, v175, v238, 0
  v_dot2_f32_bf16 v239, v239, v238, 0
  v_cvt_pk_bf16_f32 v24, v161, v225
  v_mfma_f32_32x32x16_bf16 v[144:159], v[56:59], v[76:79], v[144:159]
  v_cvt_pk_bf16_f32 v25, v163, v227
  v_cvt_pk_bf16_f32 v26, v165, v229
  v_cvt_pk_bf16_f32 v27, v167, v231
  ds_write_b128 v22, v[24:27] offset:64
  v_cvt_pk_bf16_f32 v28, v169, v233
  v_cvt_pk_bf16_f32 v29, v171, v235
  v_cvt_pk_bf16_f32 v30, v173, v237
  v_cvt_pk_bf16_f32 v31, v175, v239
  ds_write_b128 v22, v[28:31] offset:80
  v_mfma_f32_32x32x16_bf16 v[208:223], v[64:67], v[76:79], v[208:223]
  v_mfma_f32_32x32x16_bf16 v[176:191], v[36:39], v[52:55], v[176:191]
  v_mfma_f32_32x32x16_bf16 v[240:255], v[44:47], v[52:55], v[240:255]
  s_waitcnt lgkmcnt(0)
  ds_read_b128 v[192:195], v23 offset:0
  ds_read_b128 v[196:199], v23 offset:1152
  ds_read_b128 v[200:203], v23 offset:2304
  ds_read_b128 v[204:207], v23 offset:3456
  s_nop 8
  v_cvt_pk_bf16_f32 v144, v144, v145
  v_cvt_pk_bf16_f32 v208, v208, v209
  v_cvt_pk_bf16_f32 v146, v146, v147
  v_cvt_pk_bf16_f32 v210, v210, v211
  v_cvt_pk_bf16_f32 v148, v148, v149
  v_cvt_pk_bf16_f32 v212, v212, v213
  v_mfma_f32_32x32x16_bf16 v[176:191], v[84:87], v[100:103], v[176:191]
  v_cvt_pk_bf16_f32 v150, v150, v151
  v_cvt_pk_bf16_f32 v214, v214, v215
  v_cvt_pk_bf16_f32 v152, v152, v153
  v_cvt_pk_bf16_f32 v216, v216, v217
  v_cvt_pk_bf16_f32 v154, v154, v155
  v_cvt_pk_bf16_f32 v218, v218, v219
  v_cvt_pk_bf16_f32 v156, v156, v157
  v_cvt_pk_bf16_f32 v220, v220, v221
  v_cvt_pk_bf16_f32 v158, v158, v159
  v_cvt_pk_bf16_f32 v222, v222, v223
  v_max_i16_sdwa v145, v144, v12 dst_sel:WORD_0 dst_unused:UNUSED_PAD src0_sel:WORD_0 src1_sel:WORD_0
  v_max_i16_sdwa v209, v144, v12 dst_sel:WORD_1 dst_unused:UNUSED_PAD src0_sel:WORD_1 src1_sel:WORD_0
  v_mfma_f32_32x32x16_bf16 v[240:255], v[92:95], v[100:103], v[240:255]
  v_max_i16_sdwa v147, v146, v12 dst_sel:WORD_0 dst_unused:UNUSED_PAD src0_sel:WORD_0 src1_sel:WORD_0
  v_max_i16_sdwa v211, v146, v12 dst_sel:WORD_1 dst_unused:UNUSED_PAD src0_sel:WORD_1 src1_sel:WORD_0
  v_max_i16_sdwa v149, v148, v12 dst_sel:WORD_0 dst_unused:UNUSED_PAD src0_sel:WORD_0 src1_sel:WORD_0
  v_max_i16_sdwa v213, v148, v12 dst_sel:WORD_1 dst_unused:UNUSED_PAD src0_sel:WORD_1 src1_sel:WORD_0
  v_max_i16_sdwa v151, v150, v12 dst_sel:WORD_0 dst_unused:UNUSED_PAD src0_sel:WORD_0 src1_sel:WORD_0
  v_max_i16_sdwa v215, v150, v12 dst_sel:WORD_1 dst_unused:UNUSED_PAD src0_sel:WORD_1 src1_sel:WORD_0
  v_max_i16_sdwa v153, v152, v12 dst_sel:WORD_0 dst_unused:UNUSED_PAD src0_sel:WORD_0 src1_sel:WORD_0
  v_max_i16_sdwa v217, v152, v12 dst_sel:WORD_1 dst_unused:UNUSED_PAD src0_sel:WORD_1 src1_sel:WORD_0
  v_max_i16_sdwa v155, v154, v12 dst_sel:WORD_0 dst_unused:UNUSED_PAD src0_sel:WORD_0 src1_sel:WORD_0
  v_max_i16_sdwa v219, v154, v12 dst_sel:WORD_1 dst_unused:UNUSED_PAD src0_sel:WORD_1 src1_sel:WORD_0
  v_max_i16_sdwa v157, v156, v12 dst_sel:WORD_0 dst_unused:UNUSED_PAD src0_sel:WORD_0 src1_sel:WORD_0
  v_max_i16_sdwa v221, v156, v12 dst_sel:WORD_1 dst_unused:UNUSED_PAD src0_sel:WORD_1 src1_sel:WORD_0
  v_mfma_f32_32x32x16_bf16 v[176:191], v[108:111], v[124:127], v[176:191]
  v_max_i16_sdwa v159, v158, v12 dst_sel:WORD_0 dst_unused:UNUSED_PAD src0_sel:WORD_0 src1_sel:WORD_0
  v_max_i16_sdwa v223, v158, v12 dst_sel:WORD_1 dst_unused:UNUSED_PAD src0_sel:WORD_1 src1_sel:WORD_0
  s_waitcnt lgkmcnt(3)
  buffer_store_dwordx4 v[192:195], v14, s[24:27], s42 offen sc1
  s_add_u32 s42, s42, 23552
  s_waitcnt lgkmcnt(2)
  buffer_store_dwordx4 v[196:199], v14, s[24:27], s42 offen sc1
  s_add_u32 s42, s42, 23552
  s_waitcnt lgkmcnt(1)
  buffer_store_dwordx4 v[200:203], v14, s[24:27], s42 offen sc1
  s_add_u32 s42, s42, 23552
  s_waitcnt lgkmcnt(0)
  buffer_store_dwordx4 v[204:207], v14, s[24:27], s42 offen sc1
  s_add_u32 s42, s42, 23552
  v_dot2_f32_bf16 v145, v145, v208, 0
  v_dot2_f32_bf16 v209, v209, v208, 0
  v_dot2_f32_bf16 v147, v147, v210, 0
  v_dot2_f32_bf16 v211, v211, v210, 0
  v_dot2_f32_bf16 v149, v149, v212, 0
  v_dot2_f32_bf16 v213, v213, v212, 0
  v_mfma_f32_32x32x16_bf16 v[240:255], v[116:119], v[124:127], v[240:255]
  v_dot2_f32_bf16 v151, v151, v214, 0
  v_dot2_f32_bf16 v215, v215, v214, 0
  v_dot2_f32_bf16 v153, v153, v216, 0
  v_dot2_f32_bf16 v217, v217, v216, 0
  v_dot2_f32_bf16 v155, v155, v218, 0
  v_dot2_f32_bf16 v219, v219, v218, 0
  v_dot2_f32_bf16 v157, v157, v220, 0
  v_dot2_f32_bf16 v221, v221, v220, 0
  v_dot2_f32_bf16 v159, v159, v222, 0
  v_dot2_f32_bf16 v223, v223, v222, 0
  v_cvt_pk_bf16_f32 v4, v145, v209
  v_cvt_pk_bf16_f32 v5, v147, v211
  v_mfma_f32_32x32x16_bf16 v[176:191], v[60:63], v[76:79], v[176:191]
  v_cvt_pk_bf16_f32 v6, v149, v213
  v_cvt_pk_bf16_f32 v7, v151, v215
  ds_write_b128 v22, v[4:7] offset:4608
  v_cvt_pk_bf16_f32 v8, v153, v217
  v_cvt_pk_bf16_f32 v9, v155, v219
  v_cvt_pk_bf16_f32 v10, v157, v221
  v_cvt_pk_bf16_f32 v11, v159, v223
  ds_write_b128 v22, v[8:11] offset:4624
  v_mfma_f32_32x32x16_bf16 v[240:255], v[68:71], v[76:79], v[240:255]
  s_nop 15
  v_cvt_pk_bf16_f32 v176, v176, v177
  v_cvt_pk_bf16_f32 v240, v240, v241
  v_cvt_pk_bf16_f32 v178, v178, v179
  v_cvt_pk_bf16_f32 v242, v242, v243
  v_cvt_pk_bf16_f32 v180, v180, v181
  v_cvt_pk_bf16_f32 v244, v244, v245
  v_cvt_pk_bf16_f32 v182, v182, v183
  v_cvt_pk_bf16_f32 v246, v246, v247
  v_cvt_pk_bf16_f32 v184, v184, v185
  v_cvt_pk_bf16_f32 v248, v248, v249
  v_cvt_pk_bf16_f32 v186, v186, v187
  v_cvt_pk_bf16_f32 v250, v250, v251
  v_cvt_pk_bf16_f32 v188, v188, v189
  v_cvt_pk_bf16_f32 v252, v252, v253
  v_cvt_pk_bf16_f32 v190, v190, v191
  v_cvt_pk_bf16_f32 v254, v254, v255
  v_max_i16_sdwa v177, v176, v12 dst_sel:WORD_0 dst_unused:UNUSED_PAD src0_sel:WORD_0 src1_sel:WORD_0
  v_max_i16_sdwa v241, v176, v12 dst_sel:WORD_1 dst_unused:UNUSED_PAD src0_sel:WORD_1 src1_sel:WORD_0
  v_max_i16_sdwa v179, v178, v12 dst_sel:WORD_0 dst_unused:UNUSED_PAD src0_sel:WORD_0 src1_sel:WORD_0
  v_max_i16_sdwa v243, v178, v12 dst_sel:WORD_1 dst_unused:UNUSED_PAD src0_sel:WORD_1 src1_sel:WORD_0
  v_max_i16_sdwa v181, v180, v12 dst_sel:WORD_0 dst_unused:UNUSED_PAD src0_sel:WORD_0 src1_sel:WORD_0
  v_max_i16_sdwa v245, v180, v12 dst_sel:WORD_1 dst_unused:UNUSED_PAD src0_sel:WORD_1 src1_sel:WORD_0
  v_max_i16_sdwa v183, v182, v12 dst_sel:WORD_0 dst_unused:UNUSED_PAD src0_sel:WORD_0 src1_sel:WORD_0
  v_max_i16_sdwa v247, v182, v12 dst_sel:WORD_1 dst_unused:UNUSED_PAD src0_sel:WORD_1 src1_sel:WORD_0
  v_max_i16_sdwa v185, v184, v12 dst_sel:WORD_0 dst_unused:UNUSED_PAD src0_sel:WORD_0 src1_sel:WORD_0
  v_max_i16_sdwa v249, v184, v12 dst_sel:WORD_1 dst_unused:UNUSED_PAD src0_sel:WORD_1 src1_sel:WORD_0
  v_max_i16_sdwa v187, v186, v12 dst_sel:WORD_0 dst_unused:UNUSED_PAD src0_sel:WORD_0 src1_sel:WORD_0
  v_max_i16_sdwa v251, v186, v12 dst_sel:WORD_1 dst_unused:UNUSED_PAD src0_sel:WORD_1 src1_sel:WORD_0
  v_max_i16_sdwa v189, v188, v12 dst_sel:WORD_0 dst_unused:UNUSED_PAD src0_sel:WORD_0 src1_sel:WORD_0
  v_max_i16_sdwa v253, v188, v12 dst_sel:WORD_1 dst_unused:UNUSED_PAD src0_sel:WORD_1 src1_sel:WORD_0
  v_max_i16_sdwa v191, v190, v12 dst_sel:WORD_0 dst_unused:UNUSED_PAD src0_sel:WORD_0 src1_sel:WORD_0
  v_max_i16_sdwa v255, v190, v12 dst_sel:WORD_1 dst_unused:UNUSED_PAD src0_sel:WORD_1 src1_sel:WORD_0
  v_dot2_f32_bf16 v177, v177, v240, 0
  v_dot2_f32_bf16 v241, v241, v240, 0
  v_dot2_f32_bf16 v179, v179, v242, 0
  v_dot2_f32_bf16 v243, v243, v242, 0
  v_dot2_f32_bf16 v181, v181, v244, 0
  v_dot2_f32_bf16 v245, v245, v244, 0
  v_dot2_f32_bf16 v183, v183, v246, 0
  v_dot2_f32_bf16 v247, v247, v246, 0
  v_dot2_f32_bf16 v185, v185, v248, 0
  v_dot2_f32_bf16 v249, v249, v248, 0
  v_dot2_f32_bf16 v187, v187, v250, 0
  v_dot2_f32_bf16 v251, v251, v250, 0
  v_dot2_f32_bf16 v189, v189, v252, 0
  v_dot2_f32_bf16 v253, v253, v252, 0
  v_dot2_f32_bf16 v191, v191, v254, 0
  v_dot2_f32_bf16 v255, v255, v254, 0
  v_cvt_pk_bf16_f32 v24, v177, v241
  v_cvt_pk_bf16_f32 v25, v179, v243
  v_cvt_pk_bf16_f32 v26, v181, v245
  v_cvt_pk_bf16_f32 v27, v183, v247
  ds_write_b128 v22, v[24:27] offset:4672
  v_cvt_pk_bf16_f32 v28, v185, v249
  v_cvt_pk_bf16_f32 v29, v187, v251
  v_cvt_pk_bf16_f32 v30, v189, v253
  v_cvt_pk_bf16_f32 v31, v191, v255
  ds_write_b128 v22, v[28:31] offset:4688
  s_waitcnt lgkmcnt(0)
  ds_read_b128 v[192:195], v23 offset:4608
  ds_read_b128 v[196:199], v23 offset:5760
  ds_read_b128 v[200:203], v23 offset:6912
  ds_read_b128 v[204:207], v23 offset:8064
  s_waitcnt lgkmcnt(3)
  buffer_store_dwordx4 v[192:195], v14, s[24:27], s42 offen sc1
  s_add_u32 s42, s42, 23552
  s_waitcnt lgkmcnt(2)
  buffer_store_dwordx4 v[196:199], v14, s[24:27], s42 offen sc1
  s_add_u32 s42, s42, 23552
  s_waitcnt lgkmcnt(1)
  buffer_store_dwordx4 v[200:203], v14, s[24:27], s42 offen sc1
  s_add_u32 s42, s42, 23552
  s_waitcnt lgkmcnt(0)
  buffer_store_dwordx4 v[204:207], v14, s[24:27], s42 offen sc1
  s_add_u32 s42, s42, 23552
  s_endpgm
k2_conv:
  s_load_dwordx2 s[4:5], s[0:1], 48
  s_load_dwordx2 s[8:9], s[0:1], 104
  v_and_b32 v1, 63, v0
  v_lshrrev_b32 v2, 6, v0
  s_sub_u32 s28, s2, 176
  s_lshl_b32 s29, s28, 7
  v_readfirstlane_b32 s30, v2
  s_lshl_b32 s28, s28, 3
  s_add_u32 s28, s28, s30
  s_mul_i32 s31, s30, 7168
  s_add_u32 s31, s31, 32896
  s_mul_i32 s32, s28, 3072
  s_lshl_b32 s34, s28, 12
  s_lshr_b32 s35, s28, 1
  s_lshl_b32 s35, s35, 2
  v_lshlrev_b32 v3, 4, v1
  v_lshrrev_b32 v4, 3, v1
  v_and_b32 v5, 7, v1
  v_lshrrev_b32 v6, 4, v1
  v_mul_u32_u24 v4, 8320, v4
  v_add_u32 v7, 0, v6
  v_xor_b32 v7, v7, v5
  v_lshl_add_u32 v8, v7, 4, v4
  v_add_u32 v7, 4, v6
  v_xor_b32 v7, v7, v5
  v_lshl_add_u32 v9, v7, 4, v4
  v_add_u32 v9, 65536, v9
  s_mul_i32 s44, s30, 266240
  s_add_u32 s44, s44, s29
  s_add_u32 s45, s44, 131072
  s_lshl_b32 s47, s30, 12
  s_waitcnt lgkmcnt(0)
  s_load_dword s36, s[4:5], s35
  s_add_u32 s12, s8, 4718592
  s_addc_u32 s13, s9, 0
  s_mov_b32 s14, 1572864
  s_mov_b32 s15, 0x00020000
  s_add_u32 s16, s8, 2359296
  s_addc_u32 s17, s9, 0
  s_mov_b32 s18, 2129920
  s_mov_b32 s19, 0x00020000
  s_add_u32 s20, s8, 15204352
  s_addc_u32 s21, s9, 0
  s_mov_b32 s22, 2097152
  s_mov_b32 s23, 0x00020000
  s_add_u32 m0, s31, 3328
  s_nop 0
  buffer_load_dwordx4 v3, s[12:15], s32 offen offset:2048 lds
  s_add_u32 m0, s31, 1600
  s_nop 0
  buffer_load_dwordx4 v3, s[12:15], s32 offen offset:0 lds
  s_add_u32 m0, s31, 3328
  s_nop 0
  buffer_load_dwordx4 v3, s[12:15], s32 offen offset:1024 lds
  s_mov_b32 m0, s47
  s_nop 0
  buffer_load_dwordx4 v8, s[16:19], s44 offen lds
  buffer_load_dwordx4 v9, s[16:19], s44 offen offset:1024 lds
  buffer_load_dwordx4 v8, s[16:19], s45 offen offset:2048 lds
  buffer_load_dwordx4 v9, s[16:19], s45 offen offset:3072 lds
  s_sub_u32 s45, s2, 176
  s_lshr_b32 s45, s45, 3
  s_lshl_b32 s45, s45, 3
  s_add_u32 s45, s45, s30
  s_getpc_b64 s[48:49]
pc_ref2:
  s_add_u32 s48, s48, (k3_kernel - pc_ref2) & 0xffffffff
  s_addc_u32 s49, s49, ((k3_kernel - pc_ref2) >> 32) & 0xffffffff
  s_mov_b32 s50, code_end - k3_kernel
  s_mov_b32 s51, 0x00020000
  s_lshl_b32 s45, s45, 10
  buffer_load_dwordx4 v[252:255], v3, s[48:51], s45 offen
  v_mov_b32 v4, 0
  v_mov_b32 v5, 0
  v_mov_b32 v6, 0
  v_mov_b32 v7, 0
  v_add_u32 v10, 6400, v3
  v_cmp_le_u32 vcc, 48, v1
  v_add_u32 v11, 0xfffffd00, v3
  s_nop 0
  v_cndmask_b32 v10, v10, v11, vcc
  v_cmp_le_u32 vcc, 51, v1
  v_add_u32 v11, 0x790, v3
  s_nop 0
  v_cndmask_b32 v10, v10, v11, vcc
  v_add_u32 v10, s31, v10
  v_cmp_le_u32 vcc, 54, v1
  v_mov_b32 v15, 32768
  s_nop 0
  v_cndmask_b32 v238, v10, v15, vcc
  v_and_b32 v4, 15, v1
  v_lshrrev_b32 v5, 4, v1
  v_lshlrev_b32 v6, 3, v5
  v_sub_u32 v6, v6, v4
  v_lshlrev_b32 v6, 1, v6
  v_add_u32 v6, s31, v6
  v_and_b32 v7, 1, v4
  v_cmp_eq_u32 vcc, 1, v7
  v_mov_b32 v8, 4832
  v_mov_b32 v9, 2078
  v_cndmask_b32 v8, v8, v9, vcc
  v_add_u32 v8, v6, v8
  v_subrev_u32 v10, 960, v8
  v_subrev_u32 v11, 1984, v8
  v_subrev_u32 v12, 2048, v8
  v_mov_b32 v8, 6620
  v_mov_b32 v9, 6430
  v_cndmask_b32 v8, v8, v9, vcc
  v_lshlrev_b32 v9, 3, v5
  v_sub_u32 v6, v6, v9
  v_add_u32 v13, v6, v8
  v_lshl_add_u32 v6, v4, 1, v5
  v_add_u32 v7, 14, v6
  v_lshrrev_b32 v8, 1, v7
  v_and_b32 v8, 7, v8
  v_xor_b32 v8, s30, v8
  v_lshlrev_b32 v8, 4, v8
  v_lshl_add_u32 v16, v7, 7, v8
  v_add_u32 v7, 10, v6
  v_lshrrev_b32 v8, 1, v7
  v_and_b32 v8, 7, v8
  v_xor_b32 v8, s30, v8
  v_lshlrev_b32 v8, 4, v8
  v_lshl_add_u32 v17, v7, 7, v8
  v_add_u32 v7, 6, v6
  v_lshrrev_b32 v8, 1, v7
  v_and_b32 v8, 7, v8
  v_xor_b32 v8, s30, v8
  v_lshlrev_b32 v8, 4, v8
  v_lshl_add_u32 v18, v7, 7, v8
  v_add_u32 v7, 2, v6
  v_lshrrev_b32 v8, 1, v7
  v_and_b32 v8, 7, v8
  v_xor_b32 v8, s30, v8
  v_lshlrev_b32 v8, 4, v8
  v_lshl_add_u32 v19, v7, 7, v8
  v_cmp_gt_u32 vcc, 2, v6
  v_subrev_u32 v7, 2048, v16
  s_nop 0
  v_cndmask_b32 v24, v7, v15, vcc
  v_cmp_gt_u32 vcc, 6, v6
  v_subrev_u32 v7, 2048, v17
  s_nop 0
  v_cndmask_b32 v25, v7, v15, vcc
  v_cmp_gt_u32 vcc, 10, v6
  v_subrev_u32 v7, 2048, v18
  s_nop 0
  v_cndmask_b32 v26, v7, v15, vcc
  v_cmp_gt_u32 vcc, 14, v6
  v_subrev_u32 v7, 2048, v19
  s_nop 0
  v_cndmask_b32 v27, v7, v15, vcc
  v_cmp_gt_u32 vcc, 18, v6
  v_subrev_u32 v7, 4096, v16
  s_nop 0
  v_cndmask_b32 v28, v7, v15, vcc
  v_cmp_gt_u32 vcc, 22, v6
  v_subrev_u32 v7, 4096, v17
  s_nop 0
  v_cndmask_b32 v29, v7, v15, vcc
  v_cmp_gt_u32 vcc, 26, v6
  v_subrev_u32 v7, 4096, v18
  s_nop 0
  v_cndmask_b32 v30, v7, v15, vcc
  v_cmp_gt_u32 vcc, 30, v6
  v_subrev_u32 v7, 4096, v19
  s_nop 0
  v_cndmask_b32 v31, v7, v15, vcc
  v_lshrrev_b32 v7, 1, v5
  v_lshl_add_u32 v7, v4, 1, v7
  v_lshrrev_b32 v8, 1, v7
  v_and_b32 v8, 7, v8
  v_xor_b32 v8, s30, v8
  v_lshlrev_b32 v8, 4, v8
  v_lshl_add_u32 v246, v7, 7, v8
  v_and_b32 v7, 1, v5
  v_lshl_add_u32 v246, v7, 3, v246
  v_lshlrev_b32 v247, 5, v4
  v_lshl_add_u32 v247, v5, 3, v247
  v_lshlrev_b32 v8, 3, v5
  v_mov_b32 v9, 0x7f
  v_add_u32 v7, 5, v4
  v_lshlrev_b32 v240, v7, v9
  v_mov_b32 v9, 0x1ff
  v_lshlrev_b32 v241, v4, v9
  v_lshrrev_b32 v241, 4, v241
  v_mov_b32 v9, 0xf0000000
  v_lshlrev_b32 v242, v4, v9
  s_mov_b32 s40, 0x3f803f80
  s_mov_b32 s41, 0xffff
  v_lshrrev_b32 v240, v8, v240
  v_lshrrev_b32 v241, v8, v241
  v_lshrrev_b32 v242, v8, v242
  v_bfe_i32 v7, v240, 0, 1
  v_bfe_i32 v9, v240, 1, 1
  v_bfi_b32 v7, s41, v7, v9
  v_and_b32 v224, s40, v7
  v_bfe_i32 v7, v240, 2, 1
  v_bfe_i32 v9, v240, 3, 1
  v_bfi_b32 v7, s41, v7, v9
  v_and_b32 v225, s40, v7
  v_bfe_i32 v7, v240, 4, 1
  v_bfe_i32 v9, v240, 5, 1
  v_bfi_b32 v7, s41, v7, v9
  v_and_b32 v226, s40, v7
  v_bfe_i32 v7, v240, 6, 1
  v_bfe_i32 v9, v240, 7, 1
  v_bfi_b32 v7, s41, v7, v9
  v_and_b32 v227, s40, v7
  v_bfe_i32 v7, v241, 0, 1
  v_bfe_i32 v9, v241, 1, 1
  v_bfi_b32 v7, s41, v7, v9
  v_and_b32 v228, s40, v7
  v_bfe_i32 v7, v241, 2, 1
  v_bfe_i32 v9, v241, 3, 1
  v_bfi_b32 v7, s41, v7, v9
  v_and_b32 v229, s40, v7
  v_bfe_i32 v7, v241, 4, 1
  v_bfe_i32 v9, v241, 5, 1
  v_bfi_b32 v7, s41, v7, v9
  v_and_b32 v230, s40, v7
  v_bfe_i32 v7, v241, 6, 1
  v_bfe_i32 v9, v241, 7, 1
  v_bfi_b32 v7, s41, v7, v9
  v_and_b32 v231, s40, v7
  v_bfe_i32 v7, v242, 0, 1
  v_bfe_i32 v9, v242, 1, 1
  v_bfi_b32 v7, s41, v7, v9
  v_and_b32 v232, s40, v7
  v_bfe_i32 v7, v242, 2, 1
  v_bfe_i32 v9, v242, 3, 1
  v_bfi_b32 v7, s41, v7, v9
  v_and_b32 v233, s40, v7
  v_bfe_i32 v7, v242, 4, 1
  v_bfe_i32 v9, v242, 5, 1
  v_bfi_b32 v7, s41, v7, v9
  v_and_b32 v234, s40, v7
  v_bfe_i32 v7, v242, 6, 1
  v_bfe_i32 v9, v242, 7, 1
  v_bfi_b32 v7, s41, v7, v9
  v_and_b32 v235, s40, v7
  s_add_u32 s38, s31, 5376
  v_lshlrev_b32 v7, 2, v1
  v_sub_u32 v249, s38, v7
  v_lshlrev_b32 v7, 3, v1
  v_min_u32 v7, 248, v7
  v_sub_u32 v250, s38, v7
  v_lshlrev_b32 v7, 2, v1
  v_add_u32 v243, s38, v7
  v_add_u32 v248, s31, v3
  v_cmp_eq_u32 s[52:53], 63, v1
  v_lshlrev_b32 v7, 1, v1
  s_add_u32 s39, s31, 6526
  v_sub_u32 v251, s39, v7
  v_add_u32 v245, 190, v251
  v_mov_b32 v7, s38
  v_cndmask_b32 v245, v245, v7, s[52:53]
  s_mov_b32 s42, 0x03020302
  s_mov_b32 s43, 0x01000100
  s_waitcnt vmcnt(5) lgkmcnt(0)
  ds_read_b32 v180, v249 offset:508
  ds_read_u16 v181, v249 offset:512
  ds_read_b64 v[182:183], v250 offset:248
  ds_read_u16 v184, v250 offset:256
  ds_read_u16 v185, v243 offset:514
  ds_read_u16 v186, v243 offset:516
  v_mov_b32 v4, 0
  v_mov_b32 v5, 0
  v_mov_b32 v6, 0
  v_mov_b32 v7, 0
  ds_write_b128 v238, v[4:7]
  s_and_b32 s44, s28, 1
  s_lshl_b32 s45, s36, 16
  s_and_b32 s36, s36, 0xffff0000
  s_cmp_eq_u32 s44, 0
  s_cselect_b32 s36, s45, s36
  s_mov_b32 s37, s36
  s_waitcnt lgkmcnt(5)
  v_lshl_or_b32 v188, v181, 16, v181
  v_perm_b32 v189, v180, v180, s42
  v_alignbit_b32 v190, v180, v180, 16
  v_perm_b32 v191, v180, v180, s43
  v_mov_b32 v192, v188
  v_bfi_b32 v193, s41, v181, v180
  v_mov_b32 v194, v189
  v_mov_b32 v195, v191
  ds_write_b128 v248, v[188:191] offset:64
  ds_write_b128 v248, v[192:195] offset:2816
  v_lshlrev_b32 v5, 16, v181
  v_mov_b32 v6, v188
  v_mov_b32 v7, v188
  v_mov_b32 v8, 0
  v_mov_b32 v9, 0
  v_mov_b32 v196, 0
  v_mov_b32 v197, 0
  v_mov_b32 v198, v188
  v_mov_b32 v199, v188
  s_mov_b64 s[54:55], exec
  s_mov_b64 exec, 1
  ds_write_b128 v248, v[4:7] offset:48
  ds_write_b128 v248, v[196:199] offset:2800
  s_mov_b64 exec, s[54:55]
  s_waitcnt lgkmcnt(7)
  v_bfi_b32 v200, s41, v184, v183
  v_perm_b32 v201, v183, v183, s43
  v_bfi_b32 v202, s41, v183, v182
  v_perm_b32 v203, v182, v182, s43
  v_lshl_or_b32 v204, v184, 16, v184
  v_alignbit_b32 v205, v183, v183, 16
  v_mov_b32 v206, v201
  v_alignbit_b32 v207, v182, v182, 16
  s_mov_b32 exec_hi, 0
  ds_write_b128 v248, v[200:203] offset:1088
  ds_write_b128 v248, v[204:207] offset:3840
  s_mov_b64 exec, s[54:55]
  s_waitcnt lgkmcnt(7)
  ds_write_b16 v251, v186
  ds_write_b16 v245, v186
  ds_write_b16 v251, v185 offset:384
  ds_write_b16 v245, v185 offset:384
  s_waitcnt vmcnt(1) lgkmcnt(0)
  s_barrier
  ds_read_b128 v[80:83], v24
  ds_read2_b32 v[64:65], v10 offset0:240 offset1:241
  ds_read2_b32 v[66:67], v10 offset0:242 offset1:243
  ds_read_b128 v[84:87], v16 offset:2048
  ds_read2_b32 v[68:69], v10 offset0:112 offset1:113
  ds_read2_b32 v[70:71], v10 offset0:114 offset1:115
  ds_read_b128 v[88:91], v16 offset:6144
  ds_read2_b32 v[72:73], v11 offset0:240 offset1:241
  ds_read2_b32 v[74:75], v11 offset0:242 offset1:243
  ds_read_b128 v[92:95], v16 offset:10240
  ds_read2_b32 v[76:77], v11 offset0:112 offset1:113
  ds_read2_b32 v[78:79], v11 offset0:114 offset1:115
  ds_read_b128 v[96:99], v16 offset:14336
  ds_read_b128 v[100:103], v16 offset:18432
  ds_read_b128 v[104:107], v16 offset:22528
  ds_read_b128 v[108:111], v16 offset:26624
  ds_read2_b32 v[216:217], v12 offset0:0 offset1:1
  ds_read2_b32 v[218:219], v12 offset0:2 offset1:3
  s_waitcnt lgkmcnt(0)
  v_mfma_f32_16x16x32_bf16 v[32:35], v[64:67], v[80:83], 0
  ds_read_b128 v[128:131], v25
  v_mfma_f32_16x16x32_bf16 v[36:39], v[64:67], v[84:87], 0
  ds_read2_b32 v[112:113], v10 offset0:224 offset1:225
  v_mfma_f32_16x16x32_bf16 v[40:43], v[64:67], v[88:91], 0
  ds_read2_b32 v[114:115], v10 offset0:226 offset1:227
  v_mfma_f32_16x16x32_bf16 v[44:47], v[64:67], v[92:95], 0
  ds_read_b128 v[132:135], v17 offset:2048
  v_mfma_f32_16x16x32_bf16 v[48:51], v[64:67], v[96:99], 0
  ds_read2_b32 v[116:117], v10 offset0:96 offset1:97
  v_mfma_f32_16x16x32_bf16 v[52:55], v[64:67], v[100:103], 0
  ds_read2_b32 v[118:119], v10 offset0:98 offset1:99
  v_mfma_f32_16x16x32_bf16 v[56:59], v[64:67], v[104:107], 0
  ds_read_b128 v[136:139], v17 offset:6144
  v_mfma_f32_16x16x32_bf16 v[60:63], v[64:67], v[108:111], 0
  ds_read2_b32 v[120:121], v11 offset0:224 offset1:225
  v_mfma_f32_16x16x32_bf16 v[36:39], v[68:71], v[80:83], v[36:39]
  ds_read2_b32 v[122:123], v11 offset0:226 offset1:227
  v_mfma_f32_16x16x32_bf16 v[40:43], v[68:71], v[84:87], v[40:43]
  ds_read_b128 v[140:143], v17 offset:10240
  v_mfma_f32_16x16x32_bf16 v[44:47], v[68:71], v[88:91], v[44:47]
  ds_read2_b32 v[124:125], v11 offset0:96 offset1:97
  v_mfma_f32_16x16x32_bf16 v[48:51], v[68:71], v[92:95], v[48:51]
  ds_read2_b32 v[126:127], v11 offset0:98 offset1:99
  v_mfma_f32_16x16x32_bf16 v[52:55], v[68:71], v[96:99], v[52:55]
  ds_read_b128 v[144:147], v17 offset:14336
  v_mfma_f32_16x16x32_bf16 v[56:59], v[68:71], v[100:103], v[56:59]
  ds_read_b128 v[148:151], v17 offset:18432
  v_mfma_f32_16x16x32_bf16 v[60:63], v[68:71], v[104:107], v[60:63]
  ds_read_b128 v[152:155], v17 offset:22528
  v_mfma_f32_16x16x32_bf16 v[40:43], v[72:75], v[80:83], v[40:43]
  ds_read_b128 v[156:159], v17 offset:26624
  v_mfma_f32_16x16x32_bf16 v[44:47], v[72:75], v[84:87], v[44:47]
  v_mfma_f32_16x16x32_bf16 v[48:51], v[72:75], v[88:91], v[48:51]
  v_mfma_f32_16x16x32_bf16 v[52:55], v[72:75], v[92:95], v[52:55]
  v_mfma_f32_16x16x32_bf16 v[56:59], v[72:75], v[96:99], v[56:59]
  v_mfma_f32_16x16x32_bf16 v[60:63], v[72:75], v[100:103], v[60:63]
  v_mfma_f32_16x16x32_bf16 v[44:47], v[76:79], v[80:83], v[44:47]
  v_mfma_f32_16x16x32_bf16 v[48:51], v[76:79], v[84:87], v[48:51]
  v_mfma_f32_16x16x32_bf16 v[52:55], v[76:79], v[88:91], v[52:55]
  v_mfma_f32_16x16x32_bf16 v[56:59], v[76:79], v[92:95], v[56:59]
  v_mfma_f32_16x16x32_bf16 v[60:63], v[76:79], v[96:99], v[60:63]
  v_mfma_f32_16x16x32_bf16 v[48:51], v[216:219], v[80:83], v[48:51]
  v_mfma_f32_16x16x32_bf16 v[52:55], v[216:219], v[84:87], v[52:55]
  v_mfma_f32_16x16x32_bf16 v[56:59], v[216:219], v[88:91], v[56:59]
  v_mfma_f32_16x16x32_bf16 v[60:63], v[216:219], v[92:95], v[60:63]
  v_mfma_f32_16x16x32_bf16 v[176:179], v[80:83], v[224:227], 0
  v_mfma_f32_16x16x32_bf16 v[160:163], v[80:83], v[228:231], 0
  v_mfma_f32_16x16x32_bf16 v[180:183], v[84:87], v[224:227], 0
  v_mfma_f32_16x16x32_bf16 v[164:167], v[84:87], v[228:231], 0
  v_mfma_f32_16x16x32_bf16 v[184:187], v[88:91], v[224:227], 0
  v_mfma_f32_16x16x32_bf16 v[168:171], v[88:91], v[228:231], 0
  v_mfma_f32_16x16x32_bf16 v[188:191], v[92:95], v[224:227], 0
  v_mfma_f32_16x16x32_bf16 v[172:175], v[92:95], v[228:231], 0
  s_waitcnt lgkmcnt(0)
  v_mfma_f32_16x16x32_bf16 v[160:163], v[128:131], v[232:235], v[160:163]
  ds_read_b128 v[80:83], v26
  v_mfma_f32_16x16x32_bf16 v[32:35], v[112:115], v[128:131], v[32:35]
  ds_read2_b32 v[64:65], v10 offset0:208 offset1:209
  v_mfma_f32_16x16x32_bf16 v[164:167], v[132:135], v[232:235], v[164:167]
  ds_read2_b32 v[66:67], v10 offset0:210 offset1:211
  v_mfma_f32_16x16x32_bf16 v[36:39], v[112:115], v[132:135], v[36:39]
  ds_read_b128 v[84:87], v18 offset:2048
  v_mfma_f32_16x16x32_bf16 v[168:171], v[136:139], v[232:235], v[168:171]
  ds_read2_b32 v[68:69], v10 offset0:80 offset1:81
  v_mfma_f32_16x16x32_bf16 v[40:43], v[112:115], v[136:139], v[40:43]
  ds_read2_b32 v[70:71], v10 offset0:82 offset1:83
  v_mfma_f32_16x16x32_bf16 v[172:175], v[140:143], v[232:235], v[172:175]
  ds_read_b128 v[88:91], v18 offset:6144
  v_mfma_f32_16x16x32_bf16 v[44:47], v[112:115], v[140:143], v[44:47]
  ds_read2_b32 v[72:73], v11 offset0:208 offset1:209
  v_mfma_f32_16x16x32_bf16 v[48:51], v[112:115], v[144:147], v[48:51]
  ds_read2_b32 v[74:75], v11 offset0:210 offset1:211
  v_mfma_f32_16x16x32_bf16 v[52:55], v[112:115], v[148:151], v[52:55]
  ds_read_b128 v[92:95], v18 offset:10240
  v_mfma_f32_16x16x32_bf16 v[56:59], v[112:115], v[152:155], v[56:59]
  ds_read2_b32 v[76:77], v11 offset0:80 offset1:81
  v_mfma_f32_16x16x32_bf16 v[60:63], v[112:115], v[156:159], v[60:63]
  ds_read2_b32 v[78:79], v11 offset0:82 offset1:83
  v_mfma_f32_16x16x32_bf16 v[36:39], v[116:119], v[128:131], v[36:39]
  ds_read_b128 v[96:99], v18 offset:14336
  v_mfma_f32_16x16x32_bf16 v[40:43], v[116:119], v[132:135], v[40:43]
  ds_read_b128 v[100:103], v18 offset:18432
  v_mfma_f32_16x16x32_bf16 v[44:47], v[116:119], v[136:139], v[44:47]
  ds_read_b128 v[104:107], v18 offset:22528
  v_mfma_f32_16x16x32_bf16 v[48:51], v[116:119], v[140:143], v[48:51]
  ds_read_b128 v[108:111], v18 offset:26624
  v_mfma_f32_16x16x32_bf16 v[52:55], v[116:119], v[144:147], v[52:55]
  v_mfma_f32_16x16x32_bf16 v[56:59], v[116:119], v[148:151], v[56:59]
  v_mfma_f32_16x16x32_bf16 v[60:63], v[116:119], v[152:155], v[60:63]
  v_mfma_f32_16x16x32_bf16 v[40:43], v[120:123], v[128:131], v[40:43]
  v_mfma_f32_16x16x32_bf16 v[44:47], v[120:123], v[132:135], v[44:47]
  v_mfma_f32_16x16x32_bf16 v[48:51], v[120:123], v[136:139], v[48:51]
  v_mfma_f32_16x16x32_bf16 v[52:55], v[120:123], v[140:143], v[52:55]
  v_mfma_f32_16x16x32_bf16 v[56:59], v[120:123], v[144:147], v[56:59]
  v_mfma_f32_16x16x32_bf16 v[60:63], v[120:123], v[148:151], v[60:63]
  v_mfma_f32_16x16x32_bf16 v[44:47], v[124:127], v[128:131], v[44:47]
  v_mfma_f32_16x16x32_bf16 v[48:51], v[124:127], v[132:135], v[48:51]
  v_mfma_f32_16x16x32_bf16 v[52:55], v[124:127], v[136:139], v[52:55]
  v_mfma_f32_16x16x32_bf16 v[56:59], v[124:127], v[140:143], v[56:59]
  v_mfma_f32_16x16x32_bf16 v[60:63], v[124:127], v[144:147], v[60:63]
  s_waitcnt lgkmcnt(0)
  v_mfma_f32_16x16x32_bf16 v[32:35], v[64:67], v[80:83], v[32:35]
  v_cvt_pk_bf16_f32 v160, v160, v161
  v_cvt_pk_bf16_f32 v161, v162, v163
  v_mfma_f32_16x16x32_bf16 v[36:39], v[64:67], v[84:87], v[36:39]
  v_cvt_pk_bf16_f32 v162, v164, v165
  v_cvt_pk_bf16_f32 v163, v166, v167
  v_mfma_f32_16x16x32_bf16 v[40:43], v[64:67], v[88:91], v[40:43]
  v_cvt_pk_bf16_f32 v164, v168, v169
  v_cvt_pk_bf16_f32 v165, v170, v171
  v_mfma_f32_16x16x32_bf16 v[44:47], v[64:67], v[92:95], v[44:47]
  v_cvt_pk_bf16_f32 v166, v172, v173
  v_cvt_pk_bf16_f32 v167, v174, v175
  v_mfma_f32_16x16x32_bf16 v[48:51], v[64:67], v[96:99], v[48:51]
  v_cvt_pk_bf16_f32 v176, v176, v177
  v_cvt_pk_bf16_f32 v177, v178, v179
  v_mfma_f32_16x16x32_bf16 v[52:55], v[64:67], v[100:103], v[52:55]
  v_cvt_pk_bf16_f32 v178, v180, v181
  v_cvt_pk_bf16_f32 v179, v182, v183
  v_mfma_f32_16x16x32_bf16 v[56:59], v[64:67], v[104:107], v[56:59]
  v_cvt_pk_bf16_f32 v180, v184, v185
  v_cvt_pk_bf16_f32 v181, v186, v187
  v_mfma_f32_16x16x32_bf16 v[60:63], v[64:67], v[108:111], v[60:63]
  v_cvt_pk_bf16_f32 v182, v188, v189
  v_cvt_pk_bf16_f32 v183, v190, v191
  v_mfma_f32_16x16x32_bf16 v[36:39], v[68:71], v[80:83], v[36:39]
  ds_read_b128 v[128:131], v27
  ds_read2_b32 v[112:113], v10 offset0:192 offset1:193
  v_mfma_f32_16x16x32_bf16 v[40:43], v[68:71], v[84:87], v[40:43]
  ds_read2_b32 v[114:115], v10 offset0:194 offset1:195
  ds_read_b128 v[132:135], v19 offset:2048
  v_mfma_f32_16x16x32_bf16 v[44:47], v[68:71], v[88:91], v[44:47]
  ds_read2_b32 v[116:117], v10 offset0:64 offset1:65
  ds_read2_b32 v[118:119], v10 offset0:66 offset1:67
  v_mfma_f32_16x16x32_bf16 v[48:51], v[68:71], v[92:95], v[48:51]
  ds_read_b128 v[136:139], v19 offset:6144
  ds_read2_b32 v[120:121], v11 offset0:192 offset1:193
  v_mfma_f32_16x16x32_bf16 v[52:55], v[68:71], v[96:99], v[52:55]
  ds_read2_b32 v[122:123], v11 offset0:194 offset1:195
  ds_read_b128 v[140:143], v19 offset:10240
  v_mfma_f32_16x16x32_bf16 v[56:59], v[68:71], v[100:103], v[56:59]
  ds_read2_b32 v[124:125], v11 offset0:64 offset1:65
  ds_read2_b32 v[126:127], v11 offset0:66 offset1:67
  v_mfma_f32_16x16x32_bf16 v[60:63], v[68:71], v[104:107], v[60:63]
  ds_read_b128 v[144:147], v19 offset:14336
  ds_read_b128 v[148:151], v19 offset:18432
  v_mfma_f32_16x16x32_bf16 v[40:43], v[72:75], v[80:83], v[40:43]
  ds_read_b128 v[152:155], v19 offset:22528
  ds_read_b128 v[156:159], v19 offset:26624
  v_mfma_f32_16x16x32_bf16 v[44:47], v[72:75], v[84:87], v[44:47]
  ds_read2_b32 v[192:193], v13 offset0:24 offset1:25
  ds_read2_b32 v[194:195], v13 offset0:32 offset1:33
  v_mfma_f32_16x16x32_bf16 v[48:51], v[72:75], v[88:91], v[48:51]
  ds_read2_b32 v[196:197], v13 offset0:16 offset1:17
  ds_read2_b32 v[198:199], v13 offset0:24 offset1:25
  v_mfma_f32_16x16x32_bf16 v[52:55], v[72:75], v[92:95], v[52:55]
  ds_read2_b32 v[200:201], v13 offset0:8 offset1:9
  ds_read2_b32 v[202:203], v13 offset0:16 offset1:17
  v_mfma_f32_16x16x32_bf16 v[56:59], v[72:75], v[96:99], v[56:59]
  ds_read2_b32 v[204:205], v13 offset0:0 offset1:1
  ds_read2_b32 v[206:207], v13 offset0:8 offset1:9
  v_mfma_f32_16x16x32_bf16 v[60:63], v[72:75], v[100:103], v[60:63]
  v_mfma_f32_16x16x32_bf16 v[44:47], v[76:79], v[80:83], v[44:47]
  v_mfma_f32_16x16x32_bf16 v[48:51], v[76:79], v[84:87], v[48:51]
  v_mfma_f32_16x16x32_bf16 v[52:55], v[76:79], v[88:91], v[52:55]
  v_mfma_f32_16x16x32_bf16 v[56:59], v[76:79], v[92:95], v[56:59]
  v_mfma_f32_16x16x32_bf16 v[60:63], v[76:79], v[96:99], v[60:63]
  s_waitcnt lgkmcnt(0)
  v_mfma_f32_16x16x32_bf16 v[48:51], v[160:163], v[192:195], v[48:51]
  ds_read_b128 v[80:83], v28
  v_mfma_f32_16x16x32_bf16 v[52:55], v[160:163], v[196:199], v[52:55]
  ds_read2_b32 v[64:65], v10 offset0:176 offset1:177
  v_mfma_f32_16x16x32_bf16 v[56:59], v[160:163], v[200:203], v[56:59]
  ds_read2_b32 v[66:67], v10 offset0:178 offset1:179
  v_mfma_f32_16x16x32_bf16 v[56:59], v[164:167], v[192:195], v[56:59]
  ds_read_b128 v[84:87], v16 offset:0
  v_mfma_f32_16x16x32_bf16 v[60:63], v[160:163], v[204:207], v[60:63]
  ds_read2_b32 v[68:69], v10 offset0:48 offset1:49
  v_mfma_f32_16x16x32_bf16 v[60:63], v[164:167], v[196:199], v[60:63]
  ds_read2_b32 v[70:71], v10 offset0:50 offset1:51
  v_mfma_f32_16x16x32_bf16 v[32:35], v[112:115], v[128:131], v[32:35]
  ds_read_b128 v[88:91], v16 offset:4096
  v_mfma_f32_16x16x32_bf16 v[36:39], v[112:115], v[132:135], v[36:39]
  ds_read2_b32 v[72:73], v11 offset0:176 offset1:177
  v_mfma_f32_16x16x32_bf16 v[40:43], v[112:115], v[136:139], v[40:43]
  ds_read2_b32 v[74:75], v11 offset0:178 offset1:179
  v_mfma_f32_16x16x32_bf16 v[44:47], v[112:115], v[140:143], v[44:47]
  ds_read_b128 v[92:95], v16 offset:8192
  v_mfma_f32_16x16x32_bf16 v[48:51], v[112:115], v[144:147], v[48:51]
  ds_read2_b32 v[76:77], v11 offset0:48 offset1:49
  v_mfma_f32_16x16x32_bf16 v[52:55], v[112:115], v[148:151], v[52:55]
  ds_read2_b32 v[78:79], v11 offset0:50 offset1:51
  v_mfma_f32_16x16x32_bf16 v[56:59], v[112:115], v[152:155], v[56:59]
  ds_read_b128 v[96:99], v16 offset:12288
  v_mfma_f32_16x16x32_bf16 v[60:63], v[112:115], v[156:159], v[60:63]
  ds_read_b128 v[100:103], v16 offset:16384
  v_mfma_f32_16x16x32_bf16 v[36:39], v[116:119], v[128:131], v[36:39]
  ds_read_b128 v[104:107], v16 offset:20480
  v_mfma_f32_16x16x32_bf16 v[40:43], v[116:119], v[132:135], v[40:43]
  ds_read_b128 v[108:111], v16 offset:24576
  v_mfma_f32_16x16x32_bf16 v[44:47], v[116:119], v[136:139], v[44:47]
  ds_read2_b32 v[192:193], v13 offset0:120 offset1:121
  v_mfma_f32_16x16x32_bf16 v[48:51], v[116:119], v[140:143], v[48:51]
  ds_read2_b32 v[194:195], v13 offset0:128 offset1:129
  v_mfma_f32_16x16x32_bf16 v[52:55], v[116:119], v[144:147], v[52:55]
  ds_read2_b32 v[196:197], v13 offset0:112 offset1:113
  v_mfma_f32_16x16x32_bf16 v[56:59], v[116:119], v[148:151], v[56:59]
  ds_read2_b32 v[198:199], v13 offset0:120 offset1:121
  v_mfma_f32_16x16x32_bf16 v[60:63], v[116:119], v[152:155], v[60:63]
  ds_read2_b32 v[200:201], v13 offset0:104 offset1:105
  v_mfma_f32_16x16x32_bf16 v[40:43], v[120:123], v[128:131], v[40:43]
  ds_read2_b32 v[202:203], v13 offset0:112 offset1:113
  v_mfma_f32_16x16x32_bf16 v[44:47], v[120:123], v[132:135], v[44:47]
  ds_read2_b32 v[204:205], v13 offset0:96 offset1:97
  v_mfma_f32_16x16x32_bf16 v[48:51], v[120:123], v[136:139], v[48:51]
  ds_read2_b32 v[206:207], v13 offset0:104 offset1:105
  v_mfma_f32_16x16x32_bf16 v[52:55], v[120:123], v[140:143], v[52:55]
  v_mfma_f32_16x16x32_bf16 v[56:59], v[120:123], v[144:147], v[56:59]
  v_mfma_f32_16x16x32_bf16 v[60:63], v[120:123], v[148:151], v[60:63]
  v_mfma_f32_16x16x32_bf16 v[44:47], v[124:127], v[128:131], v[44:47]
  v_mfma_f32_16x16x32_bf16 v[48:51], v[124:127], v[132:135], v[48:51]
  v_mfma_f32_16x16x32_bf16 v[52:55], v[124:127], v[136:139], v[52:55]
  v_mfma_f32_16x16x32_bf16 v[56:59], v[124:127], v[140:143], v[56:59]
  v_mfma_f32_16x16x32_bf16 v[60:63], v[124:127], v[144:147], v[60:63]
  s_waitcnt lgkmcnt(0)
  v_mfma_f32_16x16x32_bf16 v[48:51], v[176:179], v[192:195], v[48:51]
  ds_read_b128 v[128:131], v29
  v_mfma_f32_16x16x32_bf16 v[52:55], v[176:179], v[196:199], v[52:55]
  ds_read2_b32 v[112:113], v10 offset0:160 offset1:161
  v_mfma_f32_16x16x32_bf16 v[56:59], v[176:179], v[200:203], v[56:59]
  ds_read2_b32 v[114:115], v10 offset0:162 offset1:163
  v_mfma_f32_16x16x32_bf16 v[56:59], v[180:183], v[192:195], v[56:59]
  ds_read_b128 v[132:135], v17 offset:0
  v_mfma_f32_16x16x32_bf16 v[60:63], v[176:179], v[204:207], v[60:63]
  ds_read2_b32 v[116:117], v10 offset0:32 offset1:33
  v_mfma_f32_16x16x32_bf16 v[60:63], v[180:183], v[196:199], v[60:63]
  ds_read2_b32 v[118:119], v10 offset0:34 offset1:35
  v_mfma_f32_16x16x32_bf16 v[32:35], v[64:67], v[80:83], v[32:35]
  ds_read_b128 v[136:139], v17 offset:4096
  v_mfma_f32_16x16x32_bf16 v[36:39], v[64:67], v[84:87], v[36:39]
  ds_read2_b32 v[120:121], v11 offset0:160 offset1:161
  v_mfma_f32_16x16x32_bf16 v[40:43], v[64:67], v[88:91], v[40:43]
  ds_read2_b32 v[122:123], v11 offset0:162 offset1:163
  v_mfma_f32_16x16x32_bf16 v[44:47], v[64:67], v[92:95], v[44:47]
  ds_read_b128 v[140:143], v17 offset:8192
  v_mfma_f32_16x16x32_bf16 v[48:51], v[64:67], v[96:99], v[48:51]
  ds_read2_b32 v[124:125], v11 offset0:32 offset1:33
  v_mfma_f32_16x16x32_bf16 v[52:55], v[64:67], v[100:103], v[52:55]
  ds_read2_b32 v[126:127], v11 offset0:34 offset1:35
  v_mfma_f32_16x16x32_bf16 v[56:59], v[64:67], v[104:107], v[56:59]
  ds_read_b128 v[144:147], v17 offset:12288
  v_mfma_f32_16x16x32_bf16 v[60:63], v[64:67], v[108:111], v[60:63]
  ds_read_b128 v[148:151], v17 offset:16384
  v_mfma_f32_16x16x32_bf16 v[36:39], v[68:71], v[80:83], v[36:39]
  ds_read_b128 v[152:155], v17 offset:20480
  v_mfma_f32_16x16x32_bf16 v[40:43], v[68:71], v[84:87], v[40:43]
  ds_read_b128 v[156:159], v17 offset:24576
  v_mfma_f32_16x16x32_bf16 v[44:47], v[68:71], v[88:91], v[44:47]
  v_mfma_f32_16x16x32_bf16 v[48:51], v[68:71], v[92:95], v[48:51]
  v_mfma_f32_16x16x32_bf16 v[52:55], v[68:71], v[96:99], v[52:55]
  v_mfma_f32_16x16x32_bf16 v[56:59], v[68:71], v[100:103], v[56:59]
  v_mfma_f32_16x16x32_bf16 v[60:63], v[68:71], v[104:107], v[60:63]
  v_mfma_f32_16x16x32_bf16 v[40:43], v[72:75], v[80:83], v[40:43]
  v_mfma_f32_16x16x32_bf16 v[44:47], v[72:75], v[84:87], v[44:47]
  v_mfma_f32_16x16x32_bf16 v[48:51], v[72:75], v[88:91], v[48:51]
  v_mfma_f32_16x16x32_bf16 v[52:55], v[72:75], v[92:95], v[52:55]
  v_mfma_f32_16x16x32_bf16 v[56:59], v[72:75], v[96:99], v[56:59]
  v_mfma_f32_16x16x32_bf16 v[60:63], v[72:75], v[100:103], v[60:63]
  v_mfma_f32_16x16x32_bf16 v[44:47], v[76:79], v[80:83], v[44:47]
  v_mfma_f32_16x16x32_bf16 v[48:51], v[76:79], v[84:87], v[48:51]
  v_mfma_f32_16x16x32_bf16 v[52:55], v[76:79], v[88:91], v[52:55]
  v_mfma_f32_16x16x32_bf16 v[56:59], v[76:79], v[92:95], v[56:59]
  v_mfma_f32_16x16x32_bf16 v[60:63], v[76:79], v[96:99], v[60:63]
  s_waitcnt lgkmcnt(0)
  v_mfma_f32_16x16x32_bf16 v[32:35], v[112:115], v[128:131], v[32:35]
  ds_read_b128 v[80:83], v30
  v_mfma_f32_16x16x32_bf16 v[36:39], v[112:115], v[132:135], v[36:39]
  ds_read2_b32 v[64:65], v10 offset0:144 offset1:145
  v_mfma_f32_16x16x32_bf16 v[40:43], v[112:115], v[136:139], v[40:43]
  ds_read2_b32 v[66:67], v10 offset0:146 offset1:147
  v_mfma_f32_16x16x32_bf16 v[44:47], v[112:115], v[140:143], v[44:47]
  ds_read_b128 v[84:87], v18 offset:0
  v_mfma_f32_16x16x32_bf16 v[48:51], v[112:115], v[144:147], v[48:51]
  ds_read2_b32 v[68:69], v10 offset0:16 offset1:17
  v_mfma_f32_16x16x32_bf16 v[52:55], v[112:115], v[148:151], v[52:55]
  ds_read2_b32 v[70:71], v10 offset0:18 offset1:19
  v_mfma_f32_16x16x32_bf16 v[56:59], v[112:115], v[152:155], v[56:59]
  ds_read_b128 v[88:91], v18 offset:4096
  v_mfma_f32_16x16x32_bf16 v[60:63], v[112:115], v[156:159], v[60:63]
  ds_read2_b32 v[72:73], v11 offset0:144 offset1:145
  v_mfma_f32_16x16x32_bf16 v[36:39], v[116:119], v[128:131], v[36:39]
  ds_read2_b32 v[74:75], v11 offset0:146 offset1:147
  v_mfma_f32_16x16x32_bf16 v[40:43], v[116:119], v[132:135], v[40:43]
  ds_read_b128 v[92:95], v18 offset:8192
  v_mfma_f32_16x16x32_bf16 v[44:47], v[116:119], v[136:139], v[44:47]
  ds_read2_b32 v[76:77], v11 offset0:16 offset1:17
  v_mfma_f32_16x16x32_bf16 v[48:51], v[116:119], v[140:143], v[48:51]
  ds_read2_b32 v[78:79], v11 offset0:18 offset1:19
  v_mfma_f32_16x16x32_bf16 v[52:55], v[116:119], v[144:147], v[52:55]
  ds_read_b128 v[96:99], v18 offset:12288
  v_mfma_f32_16x16x32_bf16 v[56:59], v[116:119], v[148:151], v[56:59]
  ds_read_b128 v[100:103], v18 offset:16384
  v_mfma_f32_16x16x32_bf16 v[60:63], v[116:119], v[152:155], v[60:63]
  ds_read_b128 v[104:107], v18 offset:20480
  v_mfma_f32_16x16x32_bf16 v[40:43], v[120:123], v[128:131], v[40:43]
  ds_read_b128 v[108:111], v18 offset:24576
  v_mfma_f32_16x16x32_bf16 v[44:47], v[120:123], v[132:135], v[44:47]
  v_mfma_f32_16x16x32_bf16 v[48:51], v[120:123], v[136:139], v[48:51]
  v_mfma_f32_16x16x32_bf16 v[52:55], v[120:123], v[140:143], v[52:55]
  v_mfma_f32_16x16x32_bf16 v[56:59], v[120:123], v[144:147], v[56:59]
  v_mfma_f32_16x16x32_bf16 v[60:63], v[120:123], v[148:151], v[60:63]
  v_mfma_f32_16x16x32_bf16 v[44:47], v[124:127], v[128:131], v[44:47]
  v_mfma_f32_16x16x32_bf16 v[48:51], v[124:127], v[132:135], v[48:51]
  v_mfma_f32_16x16x32_bf16 v[52:55], v[124:127], v[136:139], v[52:55]
  v_mfma_f32_16x16x32_bf16 v[56:59], v[124:127], v[140:143], v[56:59]
  v_mfma_f32_16x16x32_bf16 v[60:63], v[124:127], v[144:147], v[60:63]
  s_waitcnt lgkmcnt(0)
  v_mfma_f32_16x16x32_bf16 v[32:35], v[64:67], v[80:83], v[32:35]
  ds_read_b128 v[128:131], v31
  v_mfma_f32_16x16x32_bf16 v[36:39], v[64:67], v[84:87], v[36:39]
  ds_read2_b32 v[112:113], v10 offset0:128 offset1:129
  v_mfma_f32_16x16x32_bf16 v[40:43], v[64:67], v[88:91], v[40:43]
  ds_read2_b32 v[114:115], v10 offset0:130 offset1:131
  v_mfma_f32_16x16x32_bf16 v[44:47], v[64:67], v[92:95], v[44:47]
  ds_read_b128 v[132:135], v19 offset:0
  v_mfma_f32_16x16x32_bf16 v[48:51], v[64:67], v[96:99], v[48:51]
  ds_read2_b32 v[116:117], v10 offset0:0 offset1:1
  v_mfma_f32_16x16x32_bf16 v[52:55], v[64:67], v[100:103], v[52:55]
  ds_read2_b32 v[118:119], v10 offset0:2 offset1:3
  v_mfma_f32_16x16x32_bf16 v[56:59], v[64:67], v[104:107], v[56:59]
  ds_read_b128 v[136:139], v19 offset:4096
  v_mfma_f32_16x16x32_bf16 v[60:63], v[64:67], v[108:111], v[60:63]
  ds_read2_b32 v[120:121], v11 offset0:128 offset1:129
  v_mfma_f32_16x16x32_bf16 v[36:39], v[68:71], v[80:83], v[36:39]
  ds_read2_b32 v[122:123], v11 offset0:130 offset1:131
  v_mfma_f32_16x16x32_bf16 v[40:43], v[68:71], v[84:87], v[40:43]
  ds_read_b128 v[140:143], v19 offset:8192
  v_mfma_f32_16x16x32_bf16 v[44:47], v[68:71], v[88:91], v[44:47]
  ds_read2_b32 v[124:125], v11 offset0:0 offset1:1
  v_mfma_f32_16x16x32_bf16 v[48:51], v[68:71], v[92:95], v[48:51]
  ds_read2_b32 v[126:127], v11 offset0:2 offset1:3
  v_mfma_f32_16x16x32_bf16 v[52:55], v[68:71], v[96:99], v[52:55]
  ds_read_b128 v[144:147], v19 offset:12288
  v_mfma_f32_16x16x32_bf16 v[56:59], v[68:71], v[100:103], v[56:59]
  ds_read_b128 v[148:151], v19 offset:16384
  v_mfma_f32_16x16x32_bf16 v[60:63], v[68:71], v[104:107], v[60:63]
  ds_read_b128 v[152:155], v19 offset:20480
  v_mfma_f32_16x16x32_bf16 v[40:43], v[72:75], v[80:83], v[40:43]
  ds_read_b128 v[156:159], v19 offset:24576
  v_mfma_f32_16x16x32_bf16 v[44:47], v[72:75], v[84:87], v[44:47]
  ds_read_b64 v[160:161], v246 offset:0
  v_mfma_f32_16x16x32_bf16 v[48:51], v[72:75], v[88:91], v[48:51]
  ds_read_b64 v[162:163], v246 offset:4096
  v_mfma_f32_16x16x32_bf16 v[52:55], v[72:75], v[92:95], v[52:55]
  ds_read_b64 v[164:165], v246 offset:8192
  v_mfma_f32_16x16x32_bf16 v[56:59], v[72:75], v[96:99], v[56:59]
  ds_read_b64 v[166:167], v246 offset:12288
  v_mfma_f32_16x16x32_bf16 v[60:63], v[72:75], v[100:103], v[60:63]
  ds_read_b64 v[168:169], v246 offset:16384
  v_mfma_f32_16x16x32_bf16 v[44:47], v[76:79], v[80:83], v[44:47]
  ds_read_b64 v[170:171], v246 offset:20480
  v_mfma_f32_16x16x32_bf16 v[48:51], v[76:79], v[84:87], v[48:51]
  ds_read_b64 v[172:173], v246 offset:24576
  v_mfma_f32_16x16x32_bf16 v[52:55], v[76:79], v[88:91], v[52:55]
  ds_read_b64 v[174:175], v246 offset:28672
  v_mfma_f32_16x16x32_bf16 v[56:59], v[76:79], v[92:95], v[56:59]
  v_mfma_f32_16x16x32_bf16 v[60:63], v[76:79], v[96:99], v[60:63]
  s_waitcnt lgkmcnt(0)
  v_mfma_f32_16x16x32_bf16 v[32:35], v[112:115], v[128:131], v[32:35]
  v_mfma_f32_16x16x32_bf16 v[36:39], v[112:115], v[132:135], v[36:39]
  v_mfma_f32_16x16x32_bf16 v[36:39], v[116:119], v[128:131], v[36:39]
  v_mfma_f32_16x16x32_bf16 v[40:43], v[112:115], v[136:139], v[40:43]
  v_mfma_f32_16x16x32_bf16 v[40:43], v[116:119], v[132:135], v[40:43]
  v_mfma_f32_16x16x32_bf16 v[40:43], v[120:123], v[128:131], v[40:43]
  v_mfma_f32_16x16x32_bf16 v[44:47], v[112:115], v[140:143], v[44:47]
  v_mfma_f32_16x16x32_bf16 v[44:47], v[116:119], v[136:139], v[44:47]
  v_mfma_f32_16x16x32_bf16 v[44:47], v[120:123], v[132:135], v[44:47]
  v_mfma_f32_16x16x32_bf16 v[44:47], v[124:127], v[128:131], v[44:47]
  v_mfma_f32_16x16x32_bf16 v[48:51], v[112:115], v[144:147], v[48:51]
  v_lshlrev_b32 v208, 16, v160
  v_and_b32 v209, 0xffff0000, v160
  v_lshlrev_b32 v210, 16, v161
  v_and_b32 v211, 0xffff0000, v161
  v_pk_mul_f32 v[208:209], v[208:209], s[36:37]
  v_pk_mul_f32 v[210:211], v[210:211], s[36:37]
  v_mfma_f32_16x16x32_bf16 v[48:51], v[116:119], v[140:143], v[48:51]
  v_cvt_pk_bf16_f32 v160, v208, v209
  v_cvt_pk_bf16_f32 v161, v210, v211
  v_cvt_pk_bf16_f32 v213, v32, v33
  v_cvt_pk_bf16_f32 v215, v34, v35
  v_lshlrev_b32 v208, 16, v160
  v_and_b32 v209, 0xffff0000, v160
  v_mfma_f32_16x16x32_bf16 v[48:51], v[120:123], v[136:139], v[48:51]
  v_lshlrev_b32 v210, 16, v161
  v_and_b32 v211, 0xffff0000, v161
  v_lshlrev_b32 v212, 16, v213
  v_and_b32 v213, 0xffff0000, v213
  v_lshlrev_b32 v214, 16, v215
  v_and_b32 v215, 0xffff0000, v215
  v_mfma_f32_16x16x32_bf16 v[48:51], v[124:127], v[132:135], v[48:51]
  v_pk_add_f32 v[208:209], v[208:209], v[212:213]
  v_pk_add_f32 v[210:211], v[210:211], v[214:215]
  v_cvt_pk_bf16_f32 v160, v208, v209
  v_cvt_pk_bf16_f32 v161, v210, v211
  buffer_store_dwordx2 v[160:161], v247, s[20:23], s34 offen offset:0 sc1
  v_lshlrev_b32 v2, 16, v162
  v_mfma_f32_16x16x32_bf16 v[52:55], v[112:115], v[148:151], v[52:55]
  v_and_b32 v3, 0xffff0000, v162
  v_lshlrev_b32 v4, 16, v163
  v_and_b32 v5, 0xffff0000, v163
  v_pk_mul_f32 v[2:3], v[2:3], s[36:37]
  v_pk_mul_f32 v[4:5], v[4:5], s[36:37]
  v_cvt_pk_bf16_f32 v162, v2, v3
  v_mfma_f32_16x16x32_bf16 v[52:55], v[116:119], v[144:147], v[52:55]
  v_cvt_pk_bf16_f32 v163, v4, v5
  v_cvt_pk_bf16_f32 v7, v36, v37
  v_cvt_pk_bf16_f32 v9, v38, v39
  v_lshlrev_b32 v2, 16, v162
  v_and_b32 v3, 0xffff0000, v162
  v_lshlrev_b32 v4, 16, v163
  v_mfma_f32_16x16x32_bf16 v[52:55], v[120:123], v[140:143], v[52:55]
  v_and_b32 v5, 0xffff0000, v163
  v_lshlrev_b32 v6, 16, v7
  v_and_b32 v7, 0xffff0000, v7
  v_lshlrev_b32 v8, 16, v9
  v_and_b32 v9, 0xffff0000, v9
  v_pk_add_f32 v[2:3], v[2:3], v[6:7]
  v_mfma_f32_16x16x32_bf16 v[52:55], v[124:127], v[136:139], v[52:55]
  v_pk_add_f32 v[4:5], v[4:5], v[8:9]
  v_cvt_pk_bf16_f32 v162, v2, v3
  v_cvt_pk_bf16_f32 v163, v4, v5
  buffer_store_dwordx2 v[162:163], v247, s[20:23], s34 offen offset:512 sc1
  v_mfma_f32_16x16x32_bf16 v[56:59], v[112:115], v[152:155], v[56:59]
  v_lshlrev_b32 v208, 16, v164
  v_and_b32 v209, 0xffff0000, v164
  v_lshlrev_b32 v210, 16, v165
  v_and_b32 v211, 0xffff0000, v165
  v_pk_mul_f32 v[208:209], v[208:209], s[36:37]
  v_pk_mul_f32 v[210:211], v[210:211], s[36:37]
  v_mfma_f32_16x16x32_bf16 v[56:59], v[116:119], v[148:151], v[56:59]
  v_cvt_pk_bf16_f32 v164, v208, v209
  v_cvt_pk_bf16_f32 v165, v210, v211
  v_cvt_pk_bf16_f32 v213, v40, v41
  v_cvt_pk_bf16_f32 v215, v42, v43
  v_lshlrev_b32 v208, 16, v164
  v_and_b32 v209, 0xffff0000, v164
  v_mfma_f32_16x16x32_bf16 v[56:59], v[120:123], v[144:147], v[56:59]
  v_lshlrev_b32 v210, 16, v165
  v_and_b32 v211, 0xffff0000, v165
  v_lshlrev_b32 v212, 16, v213
  v_and_b32 v213, 0xffff0000, v213
  v_lshlrev_b32 v214, 16, v215
  v_and_b32 v215, 0xffff0000, v215
  v_mfma_f32_16x16x32_bf16 v[56:59], v[124:127], v[140:143], v[56:59]
  v_pk_add_f32 v[208:209], v[208:209], v[212:213]
  v_pk_add_f32 v[210:211], v[210:211], v[214:215]
  v_cvt_pk_bf16_f32 v164, v208, v209
  v_cvt_pk_bf16_f32 v165, v210, v211
  buffer_store_dwordx2 v[164:165], v247, s[20:23], s34 offen offset:1024 sc1
  v_lshlrev_b32 v2, 16, v166
  v_mfma_f32_16x16x32_bf16 v[60:63], v[112:115], v[156:159], v[60:63]
  v_and_b32 v3, 0xffff0000, v166
  v_lshlrev_b32 v4, 16, v167
  v_and_b32 v5, 0xffff0000, v167
  v_pk_mul_f32 v[2:3], v[2:3], s[36:37]
  v_pk_mul_f32 v[4:5], v[4:5], s[36:37]
  v_cvt_pk_bf16_f32 v166, v2, v3
  v_mfma_f32_16x16x32_bf16 v[60:63], v[116:119], v[152:155], v[60:63]
  v_cvt_pk_bf16_f32 v167, v4, v5
  v_cvt_pk_bf16_f32 v7, v44, v45
  v_cvt_pk_bf16_f32 v9, v46, v47
  v_lshlrev_b32 v2, 16, v166
  v_and_b32 v3, 0xffff0000, v166
  v_lshlrev_b32 v4, 16, v167
  v_mfma_f32_16x16x32_bf16 v[60:63], v[120:123], v[148:151], v[60:63]
  v_and_b32 v5, 0xffff0000, v167
  v_lshlrev_b32 v6, 16, v7
  v_and_b32 v7, 0xffff0000, v7
  v_lshlrev_b32 v8, 16, v9
  v_and_b32 v9, 0xffff0000, v9
  v_pk_add_f32 v[2:3], v[2:3], v[6:7]
  v_mfma_f32_16x16x32_bf16 v[60:63], v[124:127], v[144:147], v[60:63]
  v_pk_add_f32 v[4:5], v[4:5], v[8:9]
  v_cvt_pk_bf16_f32 v166, v2, v3
  v_cvt_pk_bf16_f32 v167, v4, v5
  buffer_store_dwordx2 v[166:167], v247, s[20:23], s34 offen offset:1536 sc1
  v_lshlrev_b32 v208, 16, v168
  v_lshlrev_b32 v2, 16, v170
  v_and_b32 v209, 0xffff0000, v168
  v_and_b32 v3, 0xffff0000, v170
  v_lshlrev_b32 v210, 16, v169
  v_lshlrev_b32 v4, 16, v171
  v_and_b32 v211, 0xffff0000, v169
  v_and_b32 v5, 0xffff0000, v171
  v_pk_mul_f32 v[208:209], v[208:209], s[36:37]
  v_pk_mul_f32 v[2:3], v[2:3], s[36:37]
  v_pk_mul_f32 v[210:211], v[210:211], s[36:37]
  v_pk_mul_f32 v[4:5], v[4:5], s[36:37]
  v_cvt_pk_bf16_f32 v168, v208, v209
  v_cvt_pk_bf16_f32 v170, v2, v3
  v_cvt_pk_bf16_f32 v169, v210, v211
  v_cvt_pk_bf16_f32 v171, v4, v5
  v_cvt_pk_bf16_f32 v213, v48, v49
  v_cvt_pk_bf16_f32 v7, v52, v53
  v_cvt_pk_bf16_f32 v215, v50, v51
  v_cvt_pk_bf16_f32 v9, v54, v55
  v_lshlrev_b32 v208, 16, v168
  v_lshlrev_b32 v2, 16, v170
  v_and_b32 v209, 0xffff0000, v168
  v_and_b32 v3, 0xffff0000, v170
  v_lshlrev_b32 v210, 16, v169
  v_lshlrev_b32 v4, 16, v171
  v_and_b32 v211, 0xffff0000, v169
  v_and_b32 v5, 0xffff0000, v171
  v_lshlrev_b32 v212, 16, v213
  v_lshlrev_b32 v6, 16, v7
  v_and_b32 v213, 0xffff0000, v213
  v_and_b32 v7, 0xffff0000, v7
  v_lshlrev_b32 v214, 16, v215
  v_lshlrev_b32 v8, 16, v9
  v_and_b32 v215, 0xffff0000, v215
  v_and_b32 v9, 0xffff0000, v9
  v_pk_add_f32 v[208:209], v[208:209], v[212:213]
  v_pk_add_f32 v[2:3], v[2:3], v[6:7]
  v_pk_add_f32 v[210:211], v[210:211], v[214:215]
  v_pk_add_f32 v[4:5], v[4:5], v[8:9]
  v_cvt_pk_bf16_f32 v168, v208, v209
  v_cvt_pk_bf16_f32 v170, v2, v3
  v_cvt_pk_bf16_f32 v169, v210, v211
  v_cvt_pk_bf16_f32 v171, v4, v5
  buffer_store_dwordx2 v[168:169], v247, s[20:23], s34 offen offset:2048 sc1
  buffer_store_dwordx2 v[170:171], v247, s[20:23], s34 offen offset:2560 sc1
  v_lshlrev_b32 v208, 16, v172
  v_lshlrev_b32 v2, 16, v174
  v_and_b32 v209, 0xffff0000, v172
  v_and_b32 v3, 0xffff0000, v174
  v_lshlrev_b32 v210, 16, v173
  v_lshlrev_b32 v4, 16, v175
  v_and_b32 v211, 0xffff0000, v173
  v_and_b32 v5, 0xffff0000, v175
  v_pk_mul_f32 v[208:209], v[208:209], s[36:37]
  v_pk_mul_f32 v[2:3], v[2:3], s[36:37]
  v_pk_mul_f32 v[210:211], v[210:211], s[36:37]
  v_pk_mul_f32 v[4:5], v[4:5], s[36:37]
  v_cvt_pk_bf16_f32 v172, v208, v209
  v_cvt_pk_bf16_f32 v174, v2, v3
  v_cvt_pk_bf16_f32 v173, v210, v211
  v_cvt_pk_bf16_f32 v175, v4, v5
  v_cvt_pk_bf16_f32 v213, v56, v57
  v_cvt_pk_bf16_f32 v7, v60, v61
  v_cvt_pk_bf16_f32 v215, v58, v59
  v_cvt_pk_bf16_f32 v9, v62, v63
  v_lshlrev_b32 v208, 16, v172
  v_lshlrev_b32 v2, 16, v174
  v_and_b32 v209, 0xffff0000, v172
  v_and_b32 v3, 0xffff0000, v174
  v_lshlrev_b32 v210, 16, v173
  v_lshlrev_b32 v4, 16, v175
  v_and_b32 v211, 0xffff0000, v173
  v_and_b32 v5, 0xffff0000, v175
  v_lshlrev_b32 v212, 16, v213
  v_lshlrev_b32 v6, 16, v7
  v_and_b32 v213, 0xffff0000, v213
  v_and_b32 v7, 0xffff0000, v7
  v_lshlrev_b32 v214, 16, v215
  v_lshlrev_b32 v8, 16, v9
  v_and_b32 v215, 0xffff0000, v215
  v_and_b32 v9, 0xffff0000, v9
  v_pk_add_f32 v[208:209], v[208:209], v[212:213]
  v_pk_add_f32 v[2:3], v[2:3], v[6:7]
  v_pk_add_f32 v[210:211], v[210:211], v[214:215]
  v_pk_add_f32 v[4:5], v[4:5], v[8:9]
  v_cvt_pk_bf16_f32 v172, v208, v209
  v_cvt_pk_bf16_f32 v174, v2, v3
  v_cvt_pk_bf16_f32 v173, v210, v211
  v_cvt_pk_bf16_f32 v175, v4, v5
  buffer_store_dwordx2 v[172:173], v247, s[20:23], s34 offen offset:3072 sc1
  buffer_store_dwordx2 v[174:175], v247, s[20:23], s34 offen offset:3584 sc1
  s_endpgm
k2_relayout:
  s_load_dwordx2 s[4:5], s[0:1], 80
  s_load_dwordx2 s[8:9], s[0:1], 104
  v_and_b32 v1, 63, v0
  v_lshrrev_b32 v2, 6, v0
  s_sub_u32 s28, s2, 240
  s_mul_i32 s28, s28, 88
  v_readfirstlane_b32 s30, v2
  v_lshlrev_b32 v3, 4, v1
  s_add_u32 s28, s28, s30
  s_lshr_b32 s31, s28, 1
  s_and_b32 s31, s31, 1
  s_lshl_b32 s31, s31, 2
  v_and_b32 v4, 7, v1
  v_xor_b32 v4, s31, v4
  v_lshrrev_b32 v5, 3, v1
  s_mov_b32 s32, 180224
  v_mul_lo_u32 v5, v5, s32
  v_lshl_add_u32 v4, v4, 4, v5
  s_lshl_b32 s33, s28, 10
  s_lshl_b32 s34, s28, 7
  s_waitcnt lgkmcnt(0)
  s_mov_b32 s12, s4
  s_mov_b32 s13, s5
  s_mov_b32 s14, 1409024
  s_mov_b32 s15, 0x00020000
  s_add_u32 s16, s8, 17301504
  s_addc_u32 s17, s9, 0
  s_mov_b32 s18, 1441792
  s_mov_b32 s19, 0x00020000
  buffer_load_dwordx4 v[8:11], v3, s[12:15], s33 offen
  s_add_u32 s33, s33, 8192
  buffer_load_dwordx4 v[12:15], v3, s[12:15], s33 offen
  s_add_u32 s33, s33, 8192
  buffer_load_dwordx4 v[16:19], v3, s[12:15], s33 offen
  s_add_u32 s33, s33, 8192
  buffer_load_dwordx4 v[20:23], v3, s[12:15], s33 offen
  s_add_u32 s33, s33, 8192
  buffer_load_dwordx4 v[24:27], v3, s[12:15], s33 offen
  s_add_u32 s33, s33, 8192
  buffer_load_dwordx4 v[28:31], v3, s[12:15], s33 offen
  s_add_u32 s33, s33, 8192
  buffer_load_dwordx4 v[32:35], v3, s[12:15], s33 offen
  s_add_u32 s33, s33, 8192
  buffer_load_dwordx4 v[36:39], v3, s[12:15], s33 offen
  s_add_u32 s33, s33, 8192
  buffer_load_dwordx4 v[40:43], v3, s[12:15], s33 offen
  s_add_u32 s33, s33, 8192
  buffer_load_dwordx4 v[44:47], v3, s[12:15], s33 offen
  s_add_u32 s33, s33, 8192
  buffer_load_dwordx4 v[48:51], v3, s[12:15], s33 offen
  s_add_u32 s33, s33, 8192
  s_waitcnt vmcnt(0)
  buffer_store_dwordx4 v[8:11], v4, s[16:19], s34 offen offset:0 sc1
  buffer_store_dwordx4 v[12:15], v4, s[16:19], s34 offen offset:1024 sc1
  buffer_store_dwordx4 v[16:19], v4, s[16:19], s34 offen offset:2048 sc1
  buffer_store_dwordx4 v[20:23], v4, s[16:19], s34 offen offset:3072 sc1
  s_add_u32 s34, s34, 4096
  buffer_store_dwordx4 v[24:27], v4, s[16:19], s34 offen offset:0 sc1
  buffer_store_dwordx4 v[28:31], v4, s[16:19], s34 offen offset:1024 sc1
  buffer_store_dwordx4 v[32:35], v4, s[16:19], s34 offen offset:2048 sc1
  buffer_store_dwordx4 v[36:39], v4, s[16:19], s34 offen offset:3072 sc1
  s_add_u32 s34, s34, 4096
  buffer_store_dwordx4 v[40:43], v4, s[16:19], s34 offen offset:0 sc1
  buffer_store_dwordx4 v[44:47], v4, s[16:19], s34 offen offset:1024 sc1
  buffer_store_dwordx4 v[48:51], v4, s[16:19], s34 offen offset:2048 sc1
  s_endpgm
k2_exit:
  s_endpgm
.p2align 8
k3_kernel:
  s_cmp_ge_u32 s2, 256
  s_cbranch_scc1 k3_exit
  s_load_dwordx2 s[4:5], s[0:1], 0
  s_load_dwordx4 s[8:11], s[0:1], 80
  s_load_dwordx2 s[6:7], s[0:1], 104
  v_and_b32 v1, 63, v0
  v_lshrrev_b32 v2, 6, v0
  s_and_b32 s32, s2, 7
  s_lshr_b32 s33, s2, 3
  s_lshl_b32 s32, s32, 8
  s_and_b32 s35, s33, 3
  s_lshl_b32 s35, s35, 6
  s_add_u32 s32, s32, s35
  s_lshr_b32 s33, s33, 2
  s_lshl_b32 s33, s33, 6
  v_readfirstlane_b32 s34, v2
  s_cmp_lt_u32 s34, 4
  s_cbranch_scc1 k3_compute
  s_sub_u32 s34, s34, 4
  v_lshrrev_b32 v3, 3, v1
  v_and_b32 v4, 7, v1
  v_lshrrev_b32 v5, 4, v1
  v_mul_u32_u24 v7, 2944, v3
  s_lshl_b32 s36, s34, 2
  v_add_u32 v6, s36, v5
  v_and_b32 v6, 7, v6
  v_xor_b32 v6, v6, v4
  v_lshl_add_u32 v8, v6, 4, v7
  v_and_b32 v6, 1, v5
  v_lshlrev_b32 v6, 2, v6
  v_xor_b32 v6, v6, v4
  v_lshlrev_b32 v6, 4, v6
  v_lshlrev_b32 v10, 4, v1
  v_lshl_add_u32 v12, v3, 12, v6
  s_lshl_b32 s36, s34, 3
  s_add_u32 s37, s36, s32
  s_mul_i32 s37, s37, 2944
  s_mul_i32 s38, s33, 2816
  s_lshl_b32 s39, s34, 10
  s_add_u32 s38, s38, s39
  s_add_u32 s39, s36, s33
  s_lshl_b32 s39, s39, 12
  s_lshl_b32 s40, s32, 1
  s_add_u32 s39, s39, s40
  s_lshl_b32 s40, s34, 10
  s_waitcnt lgkmcnt(0)
  s_add_u32 s16, s6, 17301504
  s_addc_u32 s17, s7, 0
  s_mov_b32 s18, 1441792
  s_mov_b32 s19, 0x00020000
  s_add_u32 s12, s6, 8912896
  s_addc_u32 s13, s7, 0
  s_mov_b32 s14, 6029312
  s_mov_b32 s15, 0x00020000
  s_add_u32 s20, s6, 15204352
  s_addc_u32 s21, s7, 0
  s_mov_b32 s22, 2097152
  s_mov_b32 s23, 0x00020000
  s_add_u32 m0, s40, 8192
  s_nop 0
  buffer_load_dwordx4 v10, s[16:19], s38 offen lds
  s_add_u32 m0, s40, 0
  s_add_u32 s38, s38, 8192
  buffer_load_dwordx4 v8, s[12:15], s37 offen lds
  s_add_u32 s37, s37, 128
  s_add_u32 m0, s40, 24576
  s_nop 0
  buffer_load_dwordx4 v10, s[16:19], s38 offen lds
  s_add_u32 m0, s40, 16384
  s_add_u32 s38, s38, 8192
  buffer_load_dwordx4 v8, s[12:15], s37 offen lds
  s_add_u32 s37, s37, 128
  s_add_u32 m0, s40, 40960
  s_nop 0
  buffer_load_dwordx4 v10, s[16:19], s38 offen lds
  s_add_u32 m0, s40, 32768
  s_add_u32 s38, s38, 8192
  buffer_load_dwordx4 v8, s[12:15], s37 offen lds
  s_add_u32 s37, s37, 128
  s_waitcnt vmcnt(4)
  s_barrier
  s_add_u32 m0, s40, 57344
  s_nop 0
  buffer_load_dwordx4 v10, s[16:19], s38 offen lds
  s_add_u32 m0, s40, 49152
  s_add_u32 s38, s38, 8192
  buffer_load_dwordx4 v8, s[12:15], s37 offen lds
  s_add_u32 s37, s37, 128
  s_add_u32 m0, s40, 131072
  s_nop 0
  buffer_load_dwordx4 v12, s[20:23], s39 offen lds
  s_add_u32 m0, s40, 73728
  s_nop 0
  buffer_load_dwordx4 v10, s[16:19], s38 offen lds
  s_add_u32 m0, s40, 65536
  s_add_u32 s38, s38, 8192
  buffer_load_dwordx4 v8, s[12:15], s37 offen lds
  s_add_u32 s37, s37, 128
  s_waitcnt vmcnt(7)
  s_barrier
  s_add_u32 m0, s40, 90112
  s_nop 0
  buffer_load_dwordx4 v10, s[16:19], s38 offen lds
  s_add_u32 m0, s40, 81920
  s_add_u32 s38, s38, 8192
  buffer_load_dwordx4 v8, s[12:15], s37 offen lds
  s_add_u32 s37, s37, 128
  s_waitcnt vmcnt(7)
  s_barrier
  s_add_u32 m0, s40, 106496
  s_nop 0
  buffer_load_dwordx4 v10, s[16:19], s38 offen lds
  s_add_u32 m0, s40, 98304
  s_add_u32 s38, s38, 8192
  buffer_load_dwordx4 v8, s[12:15], s37 offen lds
  s_add_u32 s37, s37, 128
  s_waitcnt vmcnt(7)
  s_barrier
  s_add_u32 m0, s40, 122880
  s_nop 0
  buffer_load_dwordx4 v10, s[16:19], s38 offen lds
  s_add_u32 m0, s40, 114688
  s_add_u32 s38, s38, 8192
  buffer_load_dwordx4 v8, s[12:15], s37 offen lds
  s_add_u32 s37, s37, 128
  s_waitcnt vmcnt(6)
  s_barrier
  s_add_u32 m0, s40, 8192
  s_nop 0
  buffer_load_dwordx4 v10, s[16:19], s38 offen lds
  s_add_u32 m0, s40, 0
  s_add_u32 s38, s38, 8192
  buffer_load_dwordx4 v8, s[12:15], s37 offen lds
  s_add_u32 s37, s37, 128
  s_waitcnt vmcnt(6)
  s_barrier
  s_add_u32 m0, s40, 24576
  s_nop 0
  buffer_load_dwordx4 v10, s[16:19], s38 offen lds
  s_add_u32 m0, s40, 16384
  s_add_u32 s38, s38, 8192
  buffer_load_dwordx4 v8, s[12:15], s37 offen lds
  s_add_u32 s37, s37, 128
  s_waitcnt vmcnt(6)
  s_barrier
  s_add_u32 m0, s40, 40960
  s_nop 0
  buffer_load_dwordx4 v10, s[16:19], s38 offen lds
  s_add_u32 m0, s40, 32768
  s_add_u32 s38, s38, 8192
  buffer_load_dwordx4 v8, s[12:15], s37 offen lds
  s_add_u32 s37, s37, 128
  s_waitcnt vmcnt(6)
  s_barrier
  s_add_u32 m0, s40, 57344
  s_nop 0
  buffer_load_dwordx4 v10, s[16:19], s38 offen lds
  s_add_u32 m0, s40, 49152
  s_add_u32 s38, s38, 8192
  buffer_load_dwordx4 v8, s[12:15], s37 offen lds
  s_add_u32 s37, s37, 128
  s_waitcnt vmcnt(6)
  s_barrier
  s_add_u32 m0, s40, 73728
  s_nop 0
  buffer_load_dwordx4 v10, s[16:19], s38 offen lds
  s_add_u32 m0, s40, 65536
  s_add_u32 s38, s38, 8192
  buffer_load_dwordx4 v8, s[12:15], s37 offen lds
  s_add_u32 s37, s37, 128
  s_waitcnt vmcnt(6)
  s_barrier
  s_add_u32 m0, s40, 90112
  s_nop 0
  buffer_load_dwordx4 v10, s[16:19], s38 offen lds
  s_add_u32 m0, s40, 81920
  s_add_u32 s38, s38, 8192
  buffer_load_dwordx4 v8, s[12:15], s37 offen lds
  s_add_u32 s37, s37, 128
  s_waitcnt vmcnt(6)
  s_barrier
  s_add_u32 m0, s40, 106496
  s_nop 0
  buffer_load_dwordx4 v10, s[16:19], s38 offen lds
  s_add_u32 m0, s40, 98304
  s_add_u32 s38, s38, 8192
  buffer_load_dwordx4 v8, s[12:15], s37 offen lds
  s_add_u32 s37, s37, 128
  s_waitcnt vmcnt(6)
  s_barrier
  s_add_u32 m0, s40, 122880
  s_nop 0
  buffer_load_dwordx4 v10, s[16:19], s38 offen lds
  s_add_u32 m0, s40, 114688
  s_add_u32 s38, s38, 8192
  buffer_load_dwordx4 v8, s[12:15], s37 offen lds
  s_add_u32 s37, s37, 128
  s_waitcnt vmcnt(6)
  s_barrier
  s_add_u32 m0, s40, 8192
  s_nop 0
  buffer_load_dwordx4 v10, s[16:19], s38 offen lds
  s_add_u32 m0, s40, 0
  s_add_u32 s38, s38, 8192
  buffer_load_dwordx4 v8, s[12:15], s37 offen lds
  s_add_u32 s37, s37, 128
  s_waitcnt vmcnt(6)
  s_barrier
  s_add_u32 m0, s40, 24576
  s_nop 0
  buffer_load_dwordx4 v10, s[16:19], s38 offen lds
  s_add_u32 m0, s40, 16384
  s_add_u32 s38, s38, 8192
  buffer_load_dwordx4 v8, s[12:15], s37 offen lds
  s_add_u32 s37, s37, 128
  s_waitcnt vmcnt(6)
  s_barrier
  s_add_u32 m0, s40, 40960
  s_nop 0
  buffer_load_dwordx4 v10, s[16:19], s38 offen lds
  s_add_u32 m0, s40, 32768
  s_add_u32 s38, s38, 8192
  buffer_load_dwordx4 v8, s[12:15], s37 offen lds
  s_add_u32 s37, s37, 128
  s_waitcnt vmcnt(6)
  s_barrier
  s_add_u32 m0, s40, 57344
  s_nop 0
  buffer_load_dwordx4 v10, s[16:19], s38 offen lds
  s_add_u32 m0, s40, 49152
  s_add_u32 s38, s38, 8192
  buffer_load_dwordx4 v8, s[12:15], s37 offen lds
  s_add_u32 s37, s37, 128
  s_waitcnt vmcnt(6)
  s_barrier
  s_add_u32 m0, s40, 73728
  s_nop 0
  buffer_load_dwordx4 v10, s[16:19], s38 offen lds
  s_add_u32 m0, s40, 65536
  s_add_u32 s38, s38, 8192
  buffer_load_dwordx4 v8, s[12:15], s37 offen lds
  s_add_u32 s37, s37, 128
  s_waitcnt vmcnt(6)
  s_barrier
  s_add_u32 m0, s40, 90112
  s_nop 0
  buffer_load_dwordx4 v10, s[16:19], s38 offen lds
  s_add_u32 m0, s40, 81920
  s_add_u32 s38, s38, 8192
  buffer_load_dwordx4 v8, s[12:15], s37 offen lds
  s_add_u32 s37, s37, 128
  s_waitcnt vmcnt(6)
  s_barrier
  s_waitcnt vmcnt(4)
  s_barrier
  s_waitcnt vmcnt(2)
  s_barrier
  s_waitcnt vmcnt(0)
  s_barrier
  s_endpgm
k3_compute:
  s_and_b32 s41, s34, 1
  s_lshr_b32 s42, s34, 1
  v_and_b32 v3, 31, v1
  v_lshrrev_b32 v4, 5, v1
  s_lshl_b32 s43, s41, 5
  s_add_u32 s43, s43, s32
  v_add_u32 v14, s43, v3
  v_lshlrev_b32 v14, 10, v14
  v_lshl_add_u32 v14, v4, 5, v14
  s_lshl_b32 s44, s42, 5
  s_add_u32 s44, s44, s33
  s_lshl_b32 s44, s44, 1
  v_lshrrev_b32 v5, 1, v3
  v_and_b32 v5, 7, v5
  v_xor_b32 v5, v5, v4
  v_lshlrev_b32 v6, 7, v3
  s_lshl_b32 s45, s41, 12
  v_add_u32 v6, s45, v6
  v_xor_b32 v7, 0, v5
  v_lshl_add_u32 v16, v7, 4, v6
  v_xor_b32 v7, 2, v5
  v_lshl_add_u32 v17, v7, 4, v6
  v_xor_b32 v7, 4, v5
  v_lshl_add_u32 v18, v7, 4, v6
  v_xor_b32 v7, 6, v5
  v_lshl_add_u32 v19, v7, 4, v6
  v_and_b32 v5, 15, v1
  v_lshrrev_b32 v6, 2, v5
  v_and_b32 v5, 3, v5
  v_lshrrev_b32 v7, 4, v1
  v_and_b32 v7, 1, v7
  v_lshlrev_b32 v21, 3, v5
  v_lshl_add_u32 v21, v7, 5, v21
  v_lshrrev_b32 v22, 1, v6
  v_xor_b32 v23, s41, v22
  v_lshl_add_u32 v21, v23, 6, v21
  v_lshl_add_u32 v23, v4, 4, v6
  v_lshl_add_u32 v21, v23, 7, v21
  s_lshl_b32 s45, s42, 12
  s_add_u32 s45, s45, 131072
  v_add_u32 v21, s45, v21
  v_and_b32 v15, 1, v5
  v_lshlrev_b32 v15, 5, v15
  v_lshl_add_u32 v15, v7, 4, v15
  v_lshrrev_b32 v5, 1, v5
  v_lshl_add_u32 v15, v5, 3, v15
  v_xor_b32 v22, s42, v22
  v_lshl_add_u32 v15, v22, 6, v15
  v_lshl_add_u32 v6, v4, 3, v6
  v_lshl_add_u32 v15, v6, 7, v15
  v_add_u32 v20, 8192, v15
  s_waitcnt lgkmcnt(0)
  s_mov_b32 s24, s4
  s_mov_b32 s25, s5
  s_mov_b32 s26, 2097152
  s_mov_b32 s27, 0x00020000
  s_mov_b32 s28, s10
  s_mov_b32 s29, s11
  s_mov_b32 s30, 2097152
  s_mov_b32 s31, 0x00020000
  buffer_load_dwordx4 v[24:27], v14, s[24:27], s44 offen
  buffer_load_dwordx4 v[28:31], v14, s[24:27], s44 offen offset:16
  s_waitcnt lgkmcnt(0)
  s_barrier
  ds_read_b64_tr_b16 v[48:49], v20 offset:0
  ds_read_b64_tr_b16 v[50:51], v20 offset:512
  ds_read_b128 v[52:55], v16 offset:0
  ds_read_b64_tr_b16 v[56:57], v20 offset:2048
  ds_read_b64_tr_b16 v[58:59], v20 offset:2560
  ds_read_b128 v[60:63], v17 offset:0
  ds_read_b64_tr_b16 v[64:65], v20 offset:4096
  ds_read_b64_tr_b16 v[66:67], v20 offset:4608
  ds_read_b128 v[68:71], v18 offset:0
  ds_read_b64_tr_b16 v[72:73], v20 offset:6144
  ds_read_b64_tr_b16 v[74:75], v20 offset:6656
  ds_read_b128 v[76:79], v19 offset:0
  s_waitcnt lgkmcnt(0)
  s_barrier
  ds_read_b64_tr_b16 v[80:81], v20 offset:16384
  ds_read_b64_tr_b16 v[82:83], v20 offset:16896
  ds_read_b128 v[84:87], v16 offset:16384
  v_mfma_f32_32x32x16_bf16 v[32:47], v[48:51], v[52:55], 0
  ds_read_b64_tr_b16 v[88:89], v20 offset:18432
  ds_read_b64_tr_b16 v[90:91], v20 offset:18944
  ds_read_b128 v[92:95], v17 offset:16384
  v_mfma_f32_32x32x16_bf16 v[32:47], v[56:59], v[60:63], v[32:47]
  ds_read_b64_tr_b16 v[96:97], v20 offset:20480
  ds_read_b64_tr_b16 v[98:99], v20 offset:20992
  ds_read_b128 v[100:103], v18 offset:16384
  v_mfma_f32_32x32x16_bf16 v[32:47], v[64:67], v[68:71], v[32:47]
  ds_read_b64_tr_b16 v[104:105], v20 offset:22528
  ds_read_b64_tr_b16 v[106:107], v20 offset:23040
  ds_read_b128 v[108:111], v19 offset:16384
  v_mfma_f32_32x32x16_bf16 v[32:47], v[72:75], v[76:79], v[32:47]
  s_waitcnt lgkmcnt(0)
  s_barrier
  ds_read_b64_tr_b16 v[48:49], v20 offset:32768
  ds_read_b64_tr_b16 v[50:51], v20 offset:33280
  ds_read_b128 v[52:55], v16 offset:32768
  v_mfma_f32_32x32x16_bf16 v[32:47], v[80:83], v[84:87], v[32:47]
  ds_read_b64_tr_b16 v[56:57], v20 offset:34816
  ds_read_b64_tr_b16 v[58:59], v20 offset:35328
  ds_read_b128 v[60:63], v17 offset:32768
  v_mfma_f32_32x32x16_bf16 v[32:47], v[88:91], v[92:95], v[32:47]
  ds_read_b64_tr_b16 v[64:65], v20 offset:36864
  ds_read_b64_tr_b16 v[66:67], v20 offset:37376
  ds_read_b128 v[68:71], v18 offset:32768
  v_mfma_f32_32x32x16_bf16 v[32:47], v[96:99], v[100:103], v[32:47]
  ds_read_b64_tr_b16 v[72:73], v20 offset:38912
  ds_read_b64_tr_b16 v[74:75], v20 offset:39424
  ds_read_b128 v[76:79], v19 offset:32768
  v_mfma_f32_32x32x16_bf16 v[32:47], v[104:107], v[108:111], v[32:47]
  s_waitcnt lgkmcnt(0)
  s_barrier
  ds_read_b64_tr_b16 v[80:81], v20 offset:49152
  ds_read_b64_tr_b16 v[82:83], v20 offset:49664
  ds_read_b128 v[84:87], v16 offset:49152
  v_mfma_f32_32x32x16_bf16 v[32:47], v[48:51], v[52:55], v[32:47]
  ds_read_b64_tr_b16 v[88:89], v20 offset:51200
  ds_read_b64_tr_b16 v[90:91], v20 offset:51712
  ds_read_b128 v[92:95], v17 offset:49152
  v_mfma_f32_32x32x16_bf16 v[32:47], v[56:59], v[60:63], v[32:47]
  ds_read_b64_tr_b16 v[96:97], v20 offset:53248
  ds_read_b64_tr_b16 v[98:99], v20 offset:53760
  ds_read_b128 v[100:103], v18 offset:49152
  v_mfma_f32_32x32x16_bf16 v[32:47], v[64:67], v[68:71], v[32:47]
  ds_read_b64_tr_b16 v[104:105], v20 offset:55296
  ds_read_b64_tr_b16 v[106:107], v20 offset:55808
  ds_read_b128 v[108:111], v19 offset:49152
  v_mfma_f32_32x32x16_bf16 v[32:47], v[72:75], v[76:79], v[32:47]
  s_waitcnt lgkmcnt(0)
  s_barrier
  v_add_u32 v16, 0x10000, v16
  v_add_u32 v17, 0x10000, v17
  v_add_u32 v18, 0x10000, v18
  v_add_u32 v19, 0x10000, v19
  v_add_u32 v20, 0x10000, v20
  ds_read_b64_tr_b16 v[48:49], v20 offset:0
  ds_read_b64_tr_b16 v[50:51], v20 offset:512
  ds_read_b128 v[52:55], v16 offset:0
  v_mfma_f32_32x32x16_bf16 v[32:47], v[80:83], v[84:87], v[32:47]
  ds_read_b64_tr_b16 v[56:57], v20 offset:2048
  ds_read_b64_tr_b16 v[58:59], v20 offset:2560
  ds_read_b128 v[60:63], v17 offset:0
  v_mfma_f32_32x32x16_bf16 v[32:47], v[88:91], v[92:95], v[32:47]
  ds_read_b64_tr_b16 v[64:65], v20 offset:4096
  ds_read_b64_tr_b16 v[66:67], v20 offset:4608
  ds_read_b128 v[68:71], v18 offset:0
  v_mfma_f32_32x32x16_bf16 v[32:47], v[96:99], v[100:103], v[32:47]
  ds_read_b64_tr_b16 v[72:73], v20 offset:6144
  ds_read_b64_tr_b16 v[74:75], v20 offset:6656
  ds_read_b128 v[76:79], v19 offset:0
  v_mfma_f32_32x32x16_bf16 v[32:47], v[104:107], v[108:111], v[32:47]
  s_waitcnt lgkmcnt(0)
  s_barrier
  ds_read_b64_tr_b16 v[80:81], v20 offset:16384
  ds_read_b64_tr_b16 v[82:83], v20 offset:16896
  ds_read_b128 v[84:87], v16 offset:16384
  v_mfma_f32_32x32x16_bf16 v[32:47], v[48:51], v[52:55], v[32:47]
  ds_read_b64_tr_b16 v[88:89], v20 offset:18432
  ds_read_b64_tr_b16 v[90:91], v20 offset:18944
  ds_read_b128 v[92:95], v17 offset:16384
  v_mfma_f32_32x32x16_bf16 v[32:47], v[56:59], v[60:63], v[32:47]
  ds_read_b64_tr_b16 v[96:97], v20 offset:20480
  ds_read_b64_tr_b16 v[98:99], v20 offset:20992
  ds_read_b128 v[100:103], v18 offset:16384
  v_mfma_f32_32x32x16_bf16 v[32:47], v[64:67], v[68:71], v[32:47]
  ds_read_b64_tr_b16 v[104:105], v20 offset:22528
  ds_read_b64_tr_b16 v[106:107], v20 offset:23040
  ds_read_b128 v[108:111], v19 offset:16384
  v_mfma_f32_32x32x16_bf16 v[32:47], v[72:75], v[76:79], v[32:47]
  s_waitcnt lgkmcnt(0)
  s_barrier
  ds_read_b64_tr_b16 v[48:49], v20 offset:32768
  ds_read_b64_tr_b16 v[50:51], v20 offset:33280
  ds_read_b128 v[52:55], v16 offset:32768
  v_mfma_f32_32x32x16_bf16 v[32:47], v[80:83], v[84:87], v[32:47]
  ds_read_b64_tr_b16 v[56:57], v20 offset:34816
  ds_read_b64_tr_b16 v[58:59], v20 offset:35328
  ds_read_b128 v[60:63], v17 offset:32768
  v_mfma_f32_32x32x16_bf16 v[32:47], v[88:91], v[92:95], v[32:47]
  ds_read_b64_tr_b16 v[64:65], v20 offset:36864
  ds_read_b64_tr_b16 v[66:67], v20 offset:37376
  ds_read_b128 v[68:71], v18 offset:32768
  v_mfma_f32_32x32x16_bf16 v[32:47], v[96:99], v[100:103], v[32:47]
  ds_read_b64_tr_b16 v[72:73], v20 offset:38912
  ds_read_b64_tr_b16 v[74:75], v20 offset:39424
  ds_read_b128 v[76:79], v19 offset:32768
  v_mfma_f32_32x32x16_bf16 v[32:47], v[104:107], v[108:111], v[32:47]
  s_waitcnt lgkmcnt(0)
  s_barrier
  ds_read_b64_tr_b16 v[80:81], v20 offset:49152
  ds_read_b64_tr_b16 v[82:83], v20 offset:49664
  ds_read_b128 v[84:87], v16 offset:49152
  v_mfma_f32_32x32x16_bf16 v[32:47], v[48:51], v[52:55], v[32:47]
  ds_read_b64_tr_b16 v[88:89], v20 offset:51200
  ds_read_b64_tr_b16 v[90:91], v20 offset:51712
  ds_read_b128 v[92:95], v17 offset:49152
  v_mfma_f32_32x32x16_bf16 v[32:47], v[56:59], v[60:63], v[32:47]
  ds_read_b64_tr_b16 v[96:97], v20 offset:53248
  ds_read_b64_tr_b16 v[98:99], v20 offset:53760
  ds_read_b128 v[100:103], v18 offset:49152
  v_mfma_f32_32x32x16_bf16 v[32:47], v[64:67], v[68:71], v[32:47]
  ds_read_b64_tr_b16 v[104:105], v20 offset:55296
  ds_read_b64_tr_b16 v[106:107], v20 offset:55808
  ds_read_b128 v[108:111], v19 offset:49152
  v_mfma_f32_32x32x16_bf16 v[32:47], v[72:75], v[76:79], v[32:47]
  s_waitcnt lgkmcnt(0)
  s_barrier
  v_add_u32 v16, 0xffff0000, v16
  v_add_u32 v17, 0xffff0000, v17
  v_add_u32 v18, 0xffff0000, v18
  v_add_u32 v19, 0xffff0000, v19
  v_add_u32 v20, 0xffff0000, v20
  ds_read_b64_tr_b16 v[48:49], v20 offset:0
  ds_read_b64_tr_b16 v[50:51], v20 offset:512
  ds_read_b128 v[52:55], v16 offset:0
  v_mfma_f32_32x32x16_bf16 v[32:47], v[80:83], v[84:87], v[32:47]
  ds_read_b64_tr_b16 v[56:57], v20 offset:2048
  ds_read_b64_tr_b16 v[58:59], v20 offset:2560
  ds_read_b128 v[60:63], v17 offset:0
  v_mfma_f32_32x32x16_bf16 v[32:47], v[88:91], v[92:95], v[32:47]
  ds_read_b64_tr_b16 v[64:65], v20 offset:4096
  ds_read_b64_tr_b16 v[66:67], v20 offset:4608
  ds_read_b128 v[68:71], v18 offset:0
  v_mfma_f32_32x32x16_bf16 v[32:47], v[96:99], v[100:103], v[32:47]
  ds_read_b64_tr_b16 v[72:73], v20 offset:6144
  ds_read_b64_tr_b16 v[74:75], v20 offset:6656
  ds_read_b128 v[76:79], v19 offset:0
  v_mfma_f32_32x32x16_bf16 v[32:47], v[104:107], v[108:111], v[32:47]
  s_waitcnt lgkmcnt(0)
  s_barrier
  ds_read_b64_tr_b16 v[80:81], v20 offset:16384
  ds_read_b64_tr_b16 v[82:83], v20 offset:16896
  ds_read_b128 v[84:87], v16 offset:16384
  v_mfma_f32_32x32x16_bf16 v[32:47], v[48:51], v[52:55], v[32:47]
  ds_read_b64_tr_b16 v[88:89], v20 offset:18432
  ds_read_b64_tr_b16 v[90:91], v20 offset:18944
  ds_read_b128 v[92:95], v17 offset:16384
  v_mfma_f32_32x32x16_bf16 v[32:47], v[56:59], v[60:63], v[32:47]
  ds_read_b64_tr_b16 v[96:97], v20 offset:20480
  ds_read_b64_tr_b16 v[98:99], v20 offset:20992
  ds_read_b128 v[100:103], v18 offset:16384
  v_mfma_f32_32x32x16_bf16 v[32:47], v[64:67], v[68:71], v[32:47]
  ds_read_b64_tr_b16 v[104:105], v20 offset:22528
  ds_read_b64_tr_b16 v[106:107], v20 offset:23040
  ds_read_b128 v[108:111], v19 offset:16384
  v_mfma_f32_32x32x16_bf16 v[32:47], v[72:75], v[76:79], v[32:47]
  s_waitcnt lgkmcnt(0)
  s_barrier
  ds_read_b64_tr_b16 v[48:49], v20 offset:32768
  ds_read_b64_tr_b16 v[50:51], v20 offset:33280
  ds_read_b128 v[52:55], v16 offset:32768
  v_mfma_f32_32x32x16_bf16 v[32:47], v[80:83], v[84:87], v[32:47]
  ds_read_b64_tr_b16 v[56:57], v20 offset:34816
  ds_read_b64_tr_b16 v[58:59], v20 offset:35328
  ds_read_b128 v[60:63], v17 offset:32768
  v_mfma_f32_32x32x16_bf16 v[32:47], v[88:91], v[92:95], v[32:47]
  ds_read_b64_tr_b16 v[64:65], v20 offset:36864
  ds_read_b64_tr_b16 v[66:67], v20 offset:37376
  ds_read_b128 v[68:71], v18 offset:32768
  v_mfma_f32_32x32x16_bf16 v[32:47], v[96:99], v[100:103], v[32:47]
  ds_read_b64_tr_b16 v[72:73], v20 offset:38912
  ds_read_b64_tr_b16 v[74:75], v20 offset:39424
  ds_read_b128 v[76:79], v19 offset:32768
  v_mfma_f32_32x32x16_bf16 v[32:47], v[104:107], v[108:111], v[32:47]
  ds_read_b64_tr_b16 v[128:129], v21 offset:0
  ds_read_b64_tr_b16 v[130:131], v21 offset:512
  ds_read_b64_tr_b16 v[132:133], v21 offset:1024
  ds_read_b64_tr_b16 v[134:135], v21 offset:1536
  s_waitcnt vmcnt(0) lgkmcnt(0)
  s_barrier
  ds_read_b64_tr_b16 v[80:81], v20 offset:49152
  ds_read_b64_tr_b16 v[82:83], v20 offset:49664
  ds_read_b128 v[84:87], v16 offset:49152
  v_mfma_f32_32x32x16_bf16 v[32:47], v[48:51], v[52:55], v[32:47]
  ds_read_b64_tr_b16 v[88:89], v20 offset:51200
  ds_read_b64_tr_b16 v[90:91], v20 offset:51712
  ds_read_b128 v[92:95], v17 offset:49152
  v_mfma_f32_32x32x16_bf16 v[32:47], v[56:59], v[60:63], v[32:47]
  ds_read_b64_tr_b16 v[96:97], v20 offset:53248
  ds_read_b64_tr_b16 v[98:99], v20 offset:53760
  ds_read_b128 v[100:103], v18 offset:49152
  v_mfma_f32_32x32x16_bf16 v[32:47], v[64:67], v[68:71], v[32:47]
  ds_read_b64_tr_b16 v[104:105], v20 offset:55296
  ds_read_b64_tr_b16 v[106:107], v20 offset:55808
  ds_read_b128 v[108:111], v19 offset:49152
  v_mfma_f32_32x32x16_bf16 v[32:47], v[72:75], v[76:79], v[32:47]
  v_lshlrev_b32 v112, 16, v24
  v_and_b32 v113, 0xffff0000, v24
  v_lshlrev_b32 v4, 16, v128
  v_and_b32 v5, 0xffff0000, v128
  v_pk_add_f32 v[112:113], v[112:113], v[4:5]
  v_cvt_pk_bf16_f32 v113, v112, v113
  v_lshlrev_b32 v112, 16, v113
  v_and_b32 v113, 0xffff0000, v113
  v_lshlrev_b32 v114, 16, v25
  v_and_b32 v115, 0xffff0000, v25
  v_lshlrev_b32 v4, 16, v129
  v_and_b32 v5, 0xffff0000, v129
  v_pk_add_f32 v[114:115], v[114:115], v[4:5]
  v_cvt_pk_bf16_f32 v115, v114, v115
  v_lshlrev_b32 v114, 16, v115
  v_and_b32 v115, 0xffff0000, v115
  s_waitcnt lgkmcnt(0)
  s_barrier
  v_add_u32 v16, 0x10000, v16
  v_add_u32 v17, 0x10000, v17
  v_add_u32 v18, 0x10000, v18
  v_add_u32 v19, 0x10000, v19
  v_add_u32 v20, 0x10000, v20
  ds_read_b64_tr_b16 v[48:49], v20 offset:0
  ds_read_b64_tr_b16 v[50:51], v20 offset:512
  ds_read_b128 v[52:55], v16 offset:0
  v_mfma_f32_32x32x16_bf16 v[32:47], v[80:83], v[84:87], v[32:47]
  ds_read_b64_tr_b16 v[56:57], v20 offset:2048
  ds_read_b64_tr_b16 v[58:59], v20 offset:2560
  ds_read_b128 v[60:63], v17 offset:0
  v_mfma_f32_32x32x16_bf16 v[32:47], v[88:91], v[92:95], v[32:47]
  ds_read_b64_tr_b16 v[64:65], v20 offset:4096
  ds_read_b64_tr_b16 v[66:67], v20 offset:4608
  ds_read_b128 v[68:71], v18 offset:0
  v_mfma_f32_32x32x16_bf16 v[32:47], v[96:99], v[100:103], v[32:47]
  ds_read_b64_tr_b16 v[72:73], v20 offset:6144
  ds_read_b64_tr_b16 v[74:75], v20 offset:6656
  ds_read_b128 v[76:79], v19 offset:0
  v_mfma_f32_32x32x16_bf16 v[32:47], v[104:107], v[108:111], v[32:47]
  v_lshlrev_b32 v116, 16, v26
  v_and_b32 v117, 0xffff0000, v26
  v_lshlrev_b32 v4, 16, v130
  v_and_b32 v5, 0xffff0000, v130
  v_pk_add_f32 v[116:117], v[116:117], v[4:5]
  v_cvt_pk_bf16_f32 v117, v116, v117
  v_lshlrev_b32 v116, 16, v117
  v_and_b32 v117, 0xffff0000, v117
  v_lshlrev_b32 v118, 16, v27
  v_and_b32 v119, 0xffff0000, v27
  v_lshlrev_b32 v4, 16, v131
  v_and_b32 v5, 0xffff0000, v131
  v_pk_add_f32 v[118:119], v[118:119], v[4:5]
  v_cvt_pk_bf16_f32 v119, v118, v119
  v_lshlrev_b32 v118, 16, v119
  v_and_b32 v119, 0xffff0000, v119
  s_waitcnt lgkmcnt(0)
  s_barrier
  ds_read_b64_tr_b16 v[80:81], v20 offset:16384
  ds_read_b64_tr_b16 v[82:83], v20 offset:16896
  ds_read_b128 v[84:87], v16 offset:16384
  v_mfma_f32_32x32x16_bf16 v[32:47], v[48:51], v[52:55], v[32:47]
  ds_read_b64_tr_b16 v[88:89], v20 offset:18432
  ds_read_b64_tr_b16 v[90:91], v20 offset:18944
  ds_read_b128 v[92:95], v17 offset:16384
  v_mfma_f32_32x32x16_bf16 v[32:47], v[56:59], v[60:63], v[32:47]
  ds_read_b64_tr_b16 v[96:97], v20 offset:20480
  ds_read_b64_tr_b16 v[98:99], v20 offset:20992
  ds_read_b128 v[100:103], v18 offset:16384
  v_mfma_f32_32x32x16_bf16 v[32:47], v[64:67], v[68:71], v[32:47]
  ds_read_b64_tr_b16 v[104:105], v20 offset:22528
  ds_read_b64_tr_b16 v[106:107], v20 offset:23040
  ds_read_b128 v[108:111], v19 offset:16384
  v_mfma_f32_32x32x16_bf16 v[32:47], v[72:75], v[76:79], v[32:47]
  v_lshlrev_b32 v120, 16, v28
  v_and_b32 v121, 0xffff0000, v28
  v_lshlrev_b32 v4, 16, v132
  v_and_b32 v5, 0xffff0000, v132
  v_pk_add_f32 v[120:121], v[120:121], v[4:5]
  v_cvt_pk_bf16_f32 v121, v120, v121
  v_lshlrev_b32 v120, 16, v121
  v_and_b32 v121, 0xffff0000, v121
  v_lshlrev_b32 v122, 16, v29
  v_and_b32 v123, 0xffff0000, v29
  v_lshlrev_b32 v4, 16, v133
  v_and_b32 v5, 0xffff0000, v133
  v_pk_add_f32 v[122:123], v[122:123], v[4:5]
  v_cvt_pk_bf16_f32 v123, v122, v123
  v_lshlrev_b32 v122, 16, v123
  v_and_b32 v123, 0xffff0000, v123
  s_waitcnt lgkmcnt(0)
  s_barrier
  ds_read_b64_tr_b16 v[48:49], v20 offset:32768
  ds_read_b64_tr_b16 v[50:51], v20 offset:33280
  ds_read_b128 v[52:55], v16 offset:32768
  v_mfma_f32_32x32x16_bf16 v[32:47], v[80:83], v[84:87], v[32:47]
  ds_read_b64_tr_b16 v[56:57], v20 offset:34816
  ds_read_b64_tr_b16 v[58:59], v20 offset:35328
  ds_read_b128 v[60:63], v17 offset:32768
  v_mfma_f32_32x32x16_bf16 v[32:47], v[88:91], v[92:95], v[32:47]
  ds_read_b64_tr_b16 v[64:65], v20 offset:36864
  ds_read_b64_tr_b16 v[66:67], v20 offset:37376
  ds_read_b128 v[68:71], v18 offset:32768
  v_mfma_f32_32x32x16_bf16 v[32:47], v[96:99], v[100:103], v[32:47]
  ds_read_b64_tr_b16 v[72:73], v20 offset:38912
  ds_read_b64_tr_b16 v[74:75], v20 offset:39424
  ds_read_b128 v[76:79], v19 offset:32768
  v_mfma_f32_32x32x16_bf16 v[32:47], v[104:107], v[108:111], v[32:47]
  v_lshlrev_b32 v124, 16, v30
  v_and_b32 v125, 0xffff0000, v30
  v_lshlrev_b32 v4, 16, v134
  v_and_b32 v5, 0xffff0000, v134
  v_pk_add_f32 v[124:125], v[124:125], v[4:5]
  v_cvt_pk_bf16_f32 v125, v124, v125
  v_lshlrev_b32 v124, 16, v125
  v_and_b32 v125, 0xffff0000, v125
  v_lshlrev_b32 v126, 16, v31
  v_and_b32 v127, 0xffff0000, v31
  v_lshlrev_b32 v4, 16, v135
  v_and_b32 v5, 0xffff0000, v135
  v_pk_add_f32 v[126:127], v[126:127], v[4:5]
  v_cvt_pk_bf16_f32 v127, v126, v127
  v_lshlrev_b32 v126, 16, v127
  v_and_b32 v127, 0xffff0000, v127
  s_waitcnt lgkmcnt(0)
  s_barrier
  ds_read_b64_tr_b16 v[80:81], v20 offset:49152
  ds_read_b64_tr_b16 v[82:83], v20 offset:49664
  ds_read_b128 v[84:87], v16 offset:49152
  v_mfma_f32_32x32x16_bf16 v[32:47], v[48:51], v[52:55], v[32:47]
  ds_read_b64_tr_b16 v[88:89], v20 offset:51200
  ds_read_b64_tr_b16 v[90:91], v20 offset:51712
  ds_read_b128 v[92:95], v17 offset:49152
  v_mfma_f32_32x32x16_bf16 v[32:47], v[56:59], v[60:63], v[32:47]
  ds_read_b64_tr_b16 v[96:97], v20 offset:53248
  ds_read_b64_tr_b16 v[98:99], v20 offset:53760
  ds_read_b128 v[100:103], v18 offset:49152
  v_mfma_f32_32x32x16_bf16 v[32:47], v[64:67], v[68:71], v[32:47]
  ds_read_b64_tr_b16 v[104:105], v20 offset:55296
  ds_read_b64_tr_b16 v[106:107], v20 offset:55808
  ds_read_b128 v[108:111], v19 offset:49152
  v_mfma_f32_32x32x16_bf16 v[32:47], v[72:75], v[76:79], v[32:47]
  s_waitcnt lgkmcnt(0)
  s_barrier
  v_add_u32 v16, 0xffff0000, v16
  v_add_u32 v17, 0xffff0000, v17
  v_add_u32 v18, 0xffff0000, v18
  v_add_u32 v19, 0xffff0000, v19
  v_add_u32 v20, 0xffff0000, v20
  ds_read_b64_tr_b16 v[48:49], v20 offset:0
  ds_read_b64_tr_b16 v[50:51], v20 offset:512
  ds_read_b128 v[52:55], v16 offset:0
  v_mfma_f32_32x32x16_bf16 v[32:47], v[80:83], v[84:87], v[32:47]
  ds_read_b64_tr_b16 v[56:57], v20 offset:2048
  ds_read_b64_tr_b16 v[58:59], v20 offset:2560
  ds_read_b128 v[60:63], v17 offset:0
  v_mfma_f32_32x32x16_bf16 v[32:47], v[88:91], v[92:95], v[32:47]
  ds_read_b64_tr_b16 v[64:65], v20 offset:4096
  ds_read_b64_tr_b16 v[66:67], v20 offset:4608
  ds_read_b128 v[68:71], v18 offset:0
  v_mfma_f32_32x32x16_bf16 v[32:47], v[96:99], v[100:103], v[32:47]
  ds_read_b64_tr_b16 v[72:73], v20 offset:6144
  ds_read_b64_tr_b16 v[74:75], v20 offset:6656
  ds_read_b128 v[76:79], v19 offset:0
  v_mfma_f32_32x32x16_bf16 v[32:47], v[104:107], v[108:111], v[32:47]
  s_waitcnt lgkmcnt(0)
  s_barrier
  ds_read_b64_tr_b16 v[80:81], v20 offset:16384
  ds_read_b64_tr_b16 v[82:83], v20 offset:16896
  ds_read_b128 v[84:87], v16 offset:16384
  v_mfma_f32_32x32x16_bf16 v[32:47], v[48:51], v[52:55], v[32:47]
  ds_read_b64_tr_b16 v[88:89], v20 offset:18432
  ds_read_b64_tr_b16 v[90:91], v20 offset:18944
  ds_read_b128 v[92:95], v17 offset:16384
  v_mfma_f32_32x32x16_bf16 v[32:47], v[56:59], v[60:63], v[32:47]
  ds_read_b64_tr_b16 v[96:97], v20 offset:20480
  ds_read_b64_tr_b16 v[98:99], v20 offset:20992
  ds_read_b128 v[100:103], v18 offset:16384
  v_mfma_f32_32x32x16_bf16 v[32:47], v[64:67], v[68:71], v[32:47]
  ds_read_b64_tr_b16 v[104:105], v20 offset:22528
  ds_read_b64_tr_b16 v[106:107], v20 offset:23040
  ds_read_b128 v[108:111], v19 offset:16384
  v_mfma_f32_32x32x16_bf16 v[32:47], v[72:75], v[76:79], v[32:47]
  s_waitcnt lgkmcnt(0)
  s_barrier
  ds_read_b64_tr_b16 v[48:49], v20 offset:32768
  ds_read_b64_tr_b16 v[50:51], v20 offset:33280
  ds_read_b128 v[52:55], v16 offset:32768
  v_mfma_f32_32x32x16_bf16 v[32:47], v[80:83], v[84:87], v[32:47]
  ds_read_b64_tr_b16 v[56:57], v20 offset:34816
  ds_read_b64_tr_b16 v[58:59], v20 offset:35328
  ds_read_b128 v[60:63], v17 offset:32768
  v_mfma_f32_32x32x16_bf16 v[32:47], v[88:91], v[92:95], v[32:47]
  ds_read_b64_tr_b16 v[64:65], v20 offset:36864
  ds_read_b64_tr_b16 v[66:67], v20 offset:37376
  ds_read_b128 v[68:71], v18 offset:32768
  v_mfma_f32_32x32x16_bf16 v[32:47], v[96:99], v[100:103], v[32:47]
  ds_read_b64_tr_b16 v[72:73], v20 offset:38912
  ds_read_b64_tr_b16 v[74:75], v20 offset:39424
  ds_read_b128 v[76:79], v19 offset:32768
  v_mfma_f32_32x32x16_bf16 v[32:47], v[104:107], v[108:111], v[32:47]
  s_waitcnt lgkmcnt(0)
  s_barrier
  ds_read_b64_tr_b16 v[80:81], v20 offset:49152
  ds_read_b64_tr_b16 v[82:83], v20 offset:49664
  ds_read_b128 v[84:87], v16 offset:49152
  v_mfma_f32_32x32x16_bf16 v[32:47], v[48:51], v[52:55], v[32:47]
  ds_read_b64_tr_b16 v[88:89], v20 offset:51200
  ds_read_b64_tr_b16 v[90:91], v20 offset:51712
  ds_read_b128 v[92:95], v17 offset:49152
  v_mfma_f32_32x32x16_bf16 v[32:47], v[56:59], v[60:63], v[32:47]
  ds_read_b64_tr_b16 v[96:97], v20 offset:53248
  ds_read_b64_tr_b16 v[98:99], v20 offset:53760
  ds_read_b128 v[100:103], v18 offset:49152
  v_mfma_f32_32x32x16_bf16 v[32:47], v[64:67], v[68:71], v[32:47]
  ds_read_b64_tr_b16 v[104:105], v20 offset:55296
  ds_read_b64_tr_b16 v[106:107], v20 offset:55808
  ds_read_b128 v[108:111], v19 offset:49152
  v_mfma_f32_32x32x16_bf16 v[32:47], v[72:75], v[76:79], v[32:47]
  s_waitcnt lgkmcnt(0)
  s_barrier
  v_add_u32 v16, 0x10000, v16
  v_add_u32 v17, 0x10000, v17
  v_add_u32 v18, 0x10000, v18
  v_add_u32 v19, 0x10000, v19
  v_add_u32 v20, 0x10000, v20
  ds_read_b64_tr_b16 v[48:49], v20 offset:0
  ds_read_b64_tr_b16 v[50:51], v20 offset:512
  ds_read_b128 v[52:55], v16 offset:0
  v_mfma_f32_32x32x16_bf16 v[32:47], v[80:83], v[84:87], v[32:47]
  ds_read_b64_tr_b16 v[56:57], v20 offset:2048
  ds_read_b64_tr_b16 v[58:59], v20 offset:2560
  ds_read_b128 v[60:63], v17 offset:0
  v_mfma_f32_32x32x16_bf16 v[32:47], v[88:91], v[92:95], v[32:47]
  ds_read_b64_tr_b16 v[64:65], v20 offset:4096
  ds_read_b64_tr_b16 v[66:67], v20 offset:4608
  ds_read_b128 v[68:71], v18 offset:0
  v_mfma_f32_32x32x16_bf16 v[32:47], v[96:99], v[100:103], v[32:47]
  ds_read_b64_tr_b16 v[72:73], v20 offset:6144
  ds_read_b64_tr_b16 v[74:75], v20 offset:6656
  ds_read_b128 v[76:79], v19 offset:0
  v_mfma_f32_32x32x16_bf16 v[32:47], v[104:107], v[108:111], v[32:47]
  s_waitcnt lgkmcnt(0)
  s_barrier
  ds_read_b64_tr_b16 v[80:81], v20 offset:16384
  ds_read_b64_tr_b16 v[82:83], v20 offset:16896
  ds_read_b128 v[84:87], v16 offset:16384
  v_mfma_f32_32x32x16_bf16 v[32:47], v[48:51], v[52:55], v[32:47]
  ds_read_b64_tr_b16 v[88:89], v20 offset:18432
  ds_read_b64_tr_b16 v[90:91], v20 offset:18944
  ds_read_b128 v[92:95], v17 offset:16384
  v_mfma_f32_32x32x16_bf16 v[32:47], v[56:59], v[60:63], v[32:47]
  ds_read_b64_tr_b16 v[96:97], v20 offset:20480
  ds_read_b64_tr_b16 v[98:99], v20 offset:20992
  ds_read_b128 v[100:103], v18 offset:16384
  v_mfma_f32_32x32x16_bf16 v[32:47], v[64:67], v[68:71], v[32:47]
  ds_read_b64_tr_b16 v[104:105], v20 offset:22528
  ds_read_b64_tr_b16 v[106:107], v20 offset:23040
  ds_read_b128 v[108:111], v19 offset:16384
  v_mfma_f32_32x32x16_bf16 v[32:47], v[72:75], v[76:79], v[32:47]
  s_waitcnt lgkmcnt(0)
  v_mfma_f32_32x32x16_bf16 v[32:47], v[80:83], v[84:87], v[32:47]
  v_mfma_f32_32x32x16_bf16 v[32:47], v[88:91], v[92:95], v[32:47]
  v_mfma_f32_32x32x16_bf16 v[32:47], v[96:99], v[100:103], v[32:47]
  v_mfma_f32_32x32x16_bf16 v[32:47], v[104:107], v[108:111], v[32:47]
  s_nop 15
  v_cvt_pk_bf16_f32 v48, v32, v33
  v_cvt_pk_bf16_f32 v49, v34, v35
  v_cvt_pk_bf16_f32 v50, v36, v37
  v_cvt_pk_bf16_f32 v51, v38, v39
  v_cvt_pk_bf16_f32 v52, v40, v41
  v_cvt_pk_bf16_f32 v53, v42, v43
  v_cvt_pk_bf16_f32 v54, v44, v45
  v_cvt_pk_bf16_f32 v55, v46, v47
  v_lshlrev_b32 v32, 16, v48
  v_and_b32 v33, 0xffff0000, v48
  v_lshlrev_b32 v34, 16, v49
  v_and_b32 v35, 0xffff0000, v49
  v_lshlrev_b32 v36, 16, v50
  v_and_b32 v37, 0xffff0000, v50
  v_lshlrev_b32 v38, 16, v51
  v_and_b32 v39, 0xffff0000, v51
  v_lshlrev_b32 v40, 16, v52
  v_and_b32 v41, 0xffff0000, v52
  v_lshlrev_b32 v42, 16, v53
  v_and_b32 v43, 0xffff0000, v53
  v_lshlrev_b32 v44, 16, v54
  v_and_b32 v45, 0xffff0000, v54
  v_lshlrev_b32 v46, 16, v55
  v_and_b32 v47, 0xffff0000, v55
  v_pk_add_f32 v[32:33], v[32:33], v[112:113]
  v_pk_add_f32 v[34:35], v[34:35], v[114:115]
  v_pk_add_f32 v[36:37], v[36:37], v[116:117]
  v_pk_add_f32 v[38:39], v[38:39], v[118:119]
  v_pk_add_f32 v[40:41], v[40:41], v[120:121]
  v_pk_add_f32 v[42:43], v[42:43], v[122:123]
  v_pk_add_f32 v[44:45], v[44:45], v[124:125]
  v_pk_add_f32 v[46:47], v[46:47], v[126:127]
  v_cvt_pk_bf16_f32 v56, v32, v33
  v_cvt_pk_bf16_f32 v57, v34, v35
  v_cvt_pk_bf16_f32 v58, v36, v37
  v_cvt_pk_bf16_f32 v59, v38, v39
  buffer_store_dwordx4 v[56:59], v14, s[28:31], s44 offen
  v_cvt_pk_bf16_f32 v60, v40, v41
  v_cvt_pk_bf16_f32 v61, v42, v43
  v_cvt_pk_bf16_f32 v62, v44, v45
  v_cvt_pk_bf16_f32 v63, v46, v47
  buffer_store_dwordx4 v[60:63], v14, s[28:31], s44 offen offset:16
k3_exit:
  s_endpgm
code_end:
.section .rodata,"a"
.p2align 6
.amdhsa_kernel k1_kernel
  .amdhsa_next_free_vgpr 164
  .amdhsa_next_free_sgpr 74
  .amdhsa_accum_offset 164
  .amdhsa_group_segment_fixed_size 0
  .amdhsa_kernarg_size 112
  .amdhsa_user_sgpr_count 2
  .amdhsa_user_sgpr_kernarg_segment_ptr 1
  .amdhsa_system_sgpr_workgroup_id_x 1
.end_amdhsa_kernel

.p2align 6
.amdhsa_kernel k2_kernel
  .amdhsa_next_free_vgpr 256
  .amdhsa_next_free_sgpr 56
  .amdhsa_accum_offset 256
  .amdhsa_group_segment_fixed_size 0
  .amdhsa_kernarg_size 112
  .amdhsa_user_sgpr_count 2
  .amdhsa_user_sgpr_kernarg_segment_ptr 1
  .amdhsa_system_sgpr_workgroup_id_x 1
.end_amdhsa_kernel

.p2align 6
.amdhsa_kernel k3_kernel
  .amdhsa_next_free_vgpr 136
  .amdhsa_next_free_sgpr 56
  .amdhsa_accum_offset 136
  .amdhsa_group_segment_fixed_size 0
  .amdhsa_kernarg_size 112
  .amdhsa_user_sgpr_count 2
  .amdhsa_user_sgpr_kernarg_segment_ptr 1
  .amdhsa_system_sgpr_workgroup_id_x 1
.end_amdhsa_kernel
```
